```python
import torch

def _softmax(x, axis=-1):
    return torch.softmax(x, dim=axis)
def _gelu(x):
    return torch.nn.functional.gelu(x, approximate="tanh")
def _silu(x):
    return torch.nn.functional.silu(x)
def _sigmoid(x):
    return torch.sigmoid(x)
def _layernorm(x, axis=-1, eps=1e-5):
    m = x.mean(dim=axis, keepdim=True)
    v = x.var(dim=axis, keepdim=True, unbiased=False)
    return (x - m) / torch.sqrt(v + eps)
def _scatter_add(tgt, idx, src, axis=0):
    return tgt.clone().index_add_(axis, idx, src)
def _segment_sum(src, seg, n):
    out = torch.zeros((n,) + src.shape[1:], dtype=src.dtype)
    return out.index_add_(0, seg, src)
def _pad(x, pw):
    flat = tuple(v for pair in reversed(pw) for v in pair)
    return torch.nn.functional.pad(x, flat)

kernel_name = 'sequential_preLN__softmax_full_mha__moe_arch_mod__prompt'

def setup_inputs():

    _w = (lambda a: (lambda t: t.to(torch.bfloat16) if t.is_floating_point() else t)(torch.as_tensor(a)))
    def _A_setup():
        B, S, D = 1, 2048, 512
        return {
            "x": _w((lambda *s: torch.randn(*s, dtype=torch.bfloat16) * 0.05)(B, S, D)),
            "wqkv": _w((lambda *s: torch.randn(*s, dtype=torch.bfloat16) * 0.05)(D, 3 * D)),
            "wo": _w((lambda *s: torch.randn(*s, dtype=torch.bfloat16) * 0.05)(D, D)),
        }
    _A_in = _A_setup()

    def _B_setup():
        B, S, D, F, C = 1, 2048, 512, 1792, 2
        return {
            "x": _w((lambda *s: torch.randn(*s, dtype=torch.bfloat16) * 0.05)(B, S, D)),
            "w_r": _w((lambda *s: torch.randn(*s, dtype=torch.bfloat16) * 0.05)(D)),
            "w_gate": _w((lambda *s: torch.randn(*s, dtype=torch.bfloat16) * 0.05)(D, F)),
            "w_up": _w((lambda *s: torch.randn(*s, dtype=torch.bfloat16) * 0.05)(D, F)),
            "w_down": _w((lambda *s: torch.randn(*s, dtype=torch.bfloat16) * 0.05)(F, D)),
        }
    _B_in = _B_setup()

    return {
        "A_x": _A_in["x"],
        "A_wqkv": _A_in["wqkv"],
        "A_wo": _A_in["wo"],
        "B_x": _B_in["x"],
        "B_w_r": _B_in["w_r"],
        "B_w_gate": _B_in["w_gate"],
        "B_w_up": _B_in["w_up"],
        "B_w_down": _B_in["w_down"],
    }

def reference(A_x, A_wqkv, A_wo, B_x, B_w_r, B_w_gate, B_w_up, B_w_down):
    def _A_ref(x, wqkv, wo):
        B, S, D = x.shape
        H = 32; Dh = D // H
        qkv = (lambda x, *d: x.permute(*d))((x @ wqkv).reshape(B, S, 3, H, Dh), 2, 0, 3, 1, 4)
        q, k, v = qkv[0], qkv[1], qkv[2]
        scale = Dh ** -0.5
        scores = torch.einsum("bhqd,bhkd->bhqk", q, k) * scale
        p = _softmax(scores, axis=-1)
        o = torch.einsum("bhqk,bhkd->bhqd", p, v)
        return (lambda x, *d: x.permute(*d))(o, 0, 2, 1, 3).reshape(B, S, D) @ wo

    def _B_ref(x, w_r, w_gate, w_up, w_down):
        B, S, D = x.shape
        C = 2
        r = x @ w_r
        idx = torch.argsort(-r, axis=-1)[:, :C]
        idx_e = (lambda x, n, axis: torch.repeat_interleave(x, n, dim=axis))(idx.reshape(B, C, 1), D, axis=2)
        x_sel = (lambda x, i, axis: torch.take_along_dim(x, i, dim=axis))(x, idx_e, axis=1)
        g = _silu(x_sel @ w_gate)
        u = x_sel @ w_up
        y = (g * u) @ w_down
        r_sel = _sigmoid((lambda x, i, axis: torch.take_along_dim(x, i, dim=axis))(r, idx, axis=1))
        y = y * r_sel.reshape(B, C, 1)
        b_off = (torch.arange(B) * S).reshape(B, 1)
        flat_idx = (idx + b_off).reshape(B * C)
        zero = (x * 0.0).reshape(B * S, D)
        upd = _scatter_add(zero, flat_idx, y.reshape(B * C, D), axis=0)
        return x + upd.reshape(B, S, D)

    x = A_x
    h = x + _A_ref(_layernorm(x, axis=-1), A_wqkv, A_wo)
    h2 = h + _B_ref(_layernorm(h, axis=-1), B_w_r, B_w_gate, B_w_up, B_w_down)
    return h2
```

```asm
; @launch kernel=k1_qkv_kernel grid=(256,1,1) block=(768,1,1) lds=117248
; @launch kernel=k2_attn_kernel grid=(256,1,1) block=(576,1,1) lds=139328
; @launch kernel=k3_proj_kernel grid=(256,1,1) block=(256,1,1) lds=65536
; @launch kernel=k4a_ffn1_kernel grid=(184,1,1) block=(1024,1,1) lds=103424
; @launch kernel=k4b_ffn2_kernel grid=(16,1,1) block=(256,1,1) lds=1024
.amdgcn_target "amdgcn-amd-amdhsa--gfx950"
.text
.globl k1_qkv_kernel
.p2align 8
.type k1_qkv_kernel,@function
k1_qkv_kernel:
    s_cmp_ge_u32 s2, 256
    s_cbranch_scc1 K1_END
    s_load_dwordx2 s[4:5], s[0:1], 0
    s_load_dwordx2 s[6:7], s[0:1], 8
    s_load_dwordx2 s[8:9], s[0:1], 80
    s_and_b32 s3, s2, 15
    s_lshr_b32 s20, s2, 4
    v_lshrrev_b32 v1, 6, v0
    v_and_b32 v2, 63, v0
    s_nop 0
    v_readfirstlane_b32 s58, v1
    v_and_b32 v3, 31, v2
    v_lshrrev_b32 v4, 5, v2
    s_nop 1
    s_and_b32 s21, s58, 3
    s_lshl_b32 s22, s20, 7
    s_lshl_b32 s23, s21, 5
    s_add_u32 s22, s22, s23
    s_lshl_b32 s29, s21, 12
    s_lshl_b32 s34, s21, 7
    s_add_u32 s34, s34, 114688
    s_lshr_b32 s59, s58, 2
    s_cmp_eq_u32 s59, 1
    s_cbranch_scc0 K1_NOTDMA
    v_lshrrev_b32 v7, 3, v2
    v_lshlrev_b32 v7, 10, v7
    v_and_b32 v8, 7, v2
    v_lshrrev_b32 v9, 4, v2
    v_xor_b32 v10, v8, v9
    v_lshl_add_u32 v5, v10, 4, v7
    v_xor_b32 v10, 4, v10
    v_lshl_add_u32 v6, v10, 4, v7
    v_add_u32 v7, 0, v2
    v_mul_u32_u24 v8, 0xaaab, v7
    v_lshrrev_b32 v8, 19, v8
    v_mul_u32_u24 v9, 12, v8
    v_sub_u32 v9, v7, v9
    v_mul_u32_u24 v8, 0xc00, v8
    v_lshl_add_u32 v10, v9, 4, v8
    v_add_u32 v7, 64, v2
    v_mul_u32_u24 v8, 0xaaab, v7
    v_lshrrev_b32 v8, 19, v8
    v_mul_u32_u24 v9, 12, v8
    v_sub_u32 v9, v7, v9
    v_mul_u32_u24 v8, 0xc00, v8
    v_lshl_add_u32 v11, v9, 4, v8
    v_add_u32 v7, 128, v2
    v_mul_u32_u24 v8, 0xaaab, v7
    v_lshrrev_b32 v8, 19, v8
    v_mul_u32_u24 v9, 12, v8
    v_sub_u32 v9, v7, v9
    v_mul_u32_u24 v8, 0xc00, v8
    v_lshl_add_u32 v12, v9, 4, v8
    s_lshl_b32 s28, s22, 10
    s_mul_i32 s30, s21, 49152
    s_mul_i32 s31, s3, 192
    s_add_u32 s30, s30, s31
    s_mul_i32 s31, s21, 3072
    s_add_u32 s31, s31, 65536
    s_waitcnt lgkmcnt(0)
    s_mov_b32 s12, s4
    s_mov_b32 s13, s5
    s_mov_b32 s14, 0x200000
    s_mov_b32 s15, 0x00020000
    s_mov_b32 s16, s6
    s_mov_b32 s17, s7
    s_mov_b32 s18, 0x180000
    s_mov_b32 s19, 0x00020000
    s_mov_b32 s54, 0
K1_HPRE:
    s_and_b32 s55, s54, 3
    s_lshl_b32 s56, s55, 14
    s_add_u32 s56, s56, s29
    s_lshl_b32 s57, s54, 7
    s_add_u32 s57, s57, s28
    s_mov_b32 m0, s56
    s_add_u32 s56, s56, 1024
    buffer_load_dwordx4 v5, s[12:15], s57 offen lds
    s_add_u32 s57, s57, 8192
    s_mov_b32 m0, s56
    s_add_u32 s56, s56, 1024
    buffer_load_dwordx4 v6, s[12:15], s57 offen lds
    s_add_u32 s57, s57, 8192
    s_mov_b32 m0, s56
    s_add_u32 s56, s56, 1024
    buffer_load_dwordx4 v5, s[12:15], s57 offen lds
    s_add_u32 s57, s57, 8192
    s_mov_b32 m0, s56
    s_add_u32 s56, s56, 1024
    buffer_load_dwordx4 v6, s[12:15], s57 offen lds
    s_add_u32 s57, s57, 8192
    s_mul_i32 s56, s55, 12288
    s_add_u32 s56, s56, s31
    s_mul_i32 s57, s54, 196608
    s_add_u32 s57, s57, s30
    s_mov_b32 m0, s56
    s_add_u32 s56, s56, 1024
    buffer_load_dwordx4 v10, s[16:19], s57 offen lds
    s_mov_b32 m0, s56
    s_add_u32 s56, s56, 1024
    buffer_load_dwordx4 v11, s[16:19], s57 offen lds
    s_mov_b32 m0, s56
    s_add_u32 s56, s56, 1024
    buffer_load_dwordx4 v12, s[16:19], s57 offen lds
    s_add_u32 s54, s54, 1
    s_cmp_lt_u32 s54, 3
    s_cbranch_scc1 K1_HPRE
    s_mov_b32 s50, 0
K1_HLOOP:
    s_cmp_lt_u32 s50, 6
    s_cbranch_scc1 K1_HW14
    s_cmp_eq_u32 s50, 6
    s_cbranch_scc1 K1_HW7
    s_waitcnt vmcnt(0)
K1_HW7:
    s_waitcnt vmcnt(7)
K1_HW14:
    s_waitcnt vmcnt(14)
    s_barrier
    s_cmp_ge_u32 s50, 5
    s_cbranch_scc1 K1_HNODMA
    s_add_u32 s54, s50, 3
    s_and_b32 s55, s54, 3
    s_lshl_b32 s56, s55, 14
    s_add_u32 s56, s56, s29
    s_lshl_b32 s57, s54, 7
    s_add_u32 s57, s57, s28
    s_mov_b32 m0, s56
    s_add_u32 s56, s56, 1024
    buffer_load_dwordx4 v5, s[12:15], s57 offen lds
    s_add_u32 s57, s57, 8192
    s_mov_b32 m0, s56
    s_add_u32 s56, s56, 1024
    buffer_load_dwordx4 v6, s[12:15], s57 offen lds
    s_add_u32 s57, s57, 8192
    s_mov_b32 m0, s56
    s_add_u32 s56, s56, 1024
    buffer_load_dwordx4 v5, s[12:15], s57 offen lds
    s_add_u32 s57, s57, 8192
    s_mov_b32 m0, s56
    s_add_u32 s56, s56, 1024
    buffer_load_dwordx4 v6, s[12:15], s57 offen lds
    s_add_u32 s57, s57, 8192
    s_mul_i32 s56, s55, 12288
    s_add_u32 s56, s56, s31
    s_mul_i32 s57, s54, 196608
    s_add_u32 s57, s57, s30
    s_mov_b32 m0, s56
    s_add_u32 s56, s56, 1024
    buffer_load_dwordx4 v10, s[16:19], s57 offen lds
    s_mov_b32 m0, s56
    s_add_u32 s56, s56, 1024
    buffer_load_dwordx4 v11, s[16:19], s57 offen lds
    s_mov_b32 m0, s56
    s_add_u32 s56, s56, 1024
    buffer_load_dwordx4 v12, s[16:19], s57 offen lds
K1_HNODMA:
    s_add_u32 s50, s50, 1
    s_cmp_lt_u32 s50, 8
    s_cbranch_scc1 K1_HLOOP
    s_branch K1_END
K1_NOTDMA:
    v_lshrrev_b32 v7, 1, v3
    v_and_b32 v7, 7, v7
    v_lshlrev_b32 v8, 7, v3
    v_add_u32 v8, s29, v8
    v_add_u32 v9, 0, v4
    v_xor_b32 v9, v9, v7
    v_lshl_add_u32 v120, v9, 4, v8
    v_add_u32 v9, 2, v4
    v_xor_b32 v9, v9, v7
    v_lshl_add_u32 v121, v9, 4, v8
    v_add_u32 v9, 4, v4
    v_xor_b32 v9, v9, v7
    v_lshl_add_u32 v122, v9, 4, v8
    v_add_u32 v9, 6, v4
    v_xor_b32 v9, v9, v7
    v_lshl_add_u32 v123, v9, 4, v8
    v_and_b32 v7, 15, v2
    v_lshrrev_b32 v8, 2, v7
    v_and_b32 v9, 3, v7
    v_lshl_add_u32 v8, v4, 3, v8
    v_mul_u32_u24 v8, 192, v8
    v_lshrrev_b32 v7, 4, v2
    v_and_b32 v7, 1, v7
    v_lshlrev_b32 v7, 5, v7
    v_lshl_add_u32 v7, v9, 3, v7
    v_add_u32 v13, v8, v7
    v_add_u32 v13, 0x10000, v13
    v_mov_b32 v64, 0
    v_mov_b32 v65, 0
    v_mov_b32 v66, 0
    v_mov_b32 v67, 0
    v_mov_b32 v68, 0
    v_mov_b32 v69, 0
    v_mov_b32 v70, 0
    v_mov_b32 v71, 0
    v_mov_b32 v72, 0
    v_mov_b32 v73, 0
    v_mov_b32 v74, 0
    v_mov_b32 v75, 0
    v_mov_b32 v76, 0
    v_mov_b32 v77, 0
    v_mov_b32 v78, 0
    v_mov_b32 v79, 0
    v_mov_b32 v80, 0
    v_mov_b32 v81, 0
    v_mov_b32 v82, 0
    v_mov_b32 v83, 0
    v_mov_b32 v84, 0
    v_mov_b32 v85, 0
    v_mov_b32 v86, 0
    v_mov_b32 v87, 0
    v_mov_b32 v88, 0
    v_mov_b32 v89, 0
    v_mov_b32 v90, 0
    v_mov_b32 v91, 0
    v_mov_b32 v92, 0
    v_mov_b32 v93, 0
    v_mov_b32 v94, 0
    v_mov_b32 v95, 0
    v_mov_b32 v96, 0
    v_mov_b32 v97, 0
    v_mov_b32 v98, 0
    v_mov_b32 v99, 0
    v_mov_b32 v100, 0
    v_mov_b32 v101, 0
    v_mov_b32 v102, 0
    v_mov_b32 v103, 0
    v_mov_b32 v104, 0
    v_mov_b32 v105, 0
    v_mov_b32 v106, 0
    v_mov_b32 v107, 0
    v_mov_b32 v108, 0
    v_mov_b32 v109, 0
    v_mov_b32 v110, 0
    v_mov_b32 v111, 0
    s_cmp_eq_u32 s59, 0
    s_cbranch_scc1 K1_COMPUTE
    v_mov_b32 v124, 0
    v_mov_b32 v125, 0
    v_mov_b32 v126, 0
    v_mov_b32 v127, 0
    v_mov_b32 v128, 0
    v_mov_b32 v129, 0
    v_mov_b32 v130, 0
    v_mov_b32 v131, 0
    v_mov_b32 v132, 0x3f803f80
    v_mov_b32 v133, 0x3f803f80
    v_mov_b32 v134, 0x3f803f80
    v_mov_b32 v135, 0x3f803f80
    s_mul_i32 s60, s21, 3072
    v_add_u32 v13, s60, v13
    s_mov_b32 s50, 0
K1_SLOOP:
    s_and_b32 s51, s50, 3
    s_lshl_b32 s52, s51, 14
    s_mul_i32 s53, s51, 12288
    v_add_u32 v136, s52, v120
    v_add_u32 v137, s52, v121
    v_add_u32 v138, s52, v122
    v_add_u32 v139, s52, v123
    v_add_u32 v14, s53, v13
    s_barrier
    ds_read_b128 v[32:35], v136
    ds_read_b128 v[36:39], v137
    ds_read_b128 v[40:43], v138
    ds_read_b128 v[44:47], v139
    ds_read_b64_tr_b16 v[48:49], v14 offset:0
    ds_read_b64_tr_b16 v[50:51], v14 offset:768
    ds_read_b64_tr_b16 v[52:53], v14 offset:64
    ds_read_b64_tr_b16 v[54:55], v14 offset:832
    ds_read_b64_tr_b16 v[56:57], v14 offset:128
    ds_read_b64_tr_b16 v[58:59], v14 offset:896
    s_waitcnt lgkmcnt(9)
    v_lshlrev_b32 v140, 16, v32
    v_and_b32 v141, 0xffff0000, v32
    v_add_f32 v124, v124, v140
    v_add_f32 v126, v126, v141
    v_fmac_f32 v128, v140, v140
    v_fmac_f32 v130, v141, v141
    v_lshlrev_b32 v142, 16, v33
    v_and_b32 v143, 0xffff0000, v33
    v_add_f32 v125, v125, v142
    v_add_f32 v127, v127, v143
    v_fmac_f32 v129, v142, v142
    v_fmac_f32 v131, v143, v143
    v_lshlrev_b32 v144, 16, v34
    v_and_b32 v145, 0xffff0000, v34
    v_add_f32 v124, v124, v144
    v_add_f32 v126, v126, v145
    v_fmac_f32 v128, v144, v144
    v_fmac_f32 v130, v145, v145
    v_lshlrev_b32 v146, 16, v35
    v_and_b32 v147, 0xffff0000, v35
    v_add_f32 v125, v125, v146
    v_add_f32 v127, v127, v147
    v_fmac_f32 v129, v146, v146
    v_fmac_f32 v131, v147, v147
    s_waitcnt lgkmcnt(8)
    v_lshlrev_b32 v140, 16, v36
    v_and_b32 v141, 0xffff0000, v36
    v_add_f32 v124, v124, v140
    v_add_f32 v126, v126, v141
    v_fmac_f32 v128, v140, v140
    v_fmac_f32 v130, v141, v141
    v_lshlrev_b32 v142, 16, v37
    v_and_b32 v143, 0xffff0000, v37
    v_add_f32 v125, v125, v142
    v_add_f32 v127, v127, v143
    v_fmac_f32 v129, v142, v142
    v_fmac_f32 v131, v143, v143
    v_lshlrev_b32 v144, 16, v38
    v_and_b32 v145, 0xffff0000, v38
    v_add_f32 v124, v124, v144
    v_add_f32 v126, v126, v145
    v_fmac_f32 v128, v144, v144
    v_fmac_f32 v130, v145, v145
    v_lshlrev_b32 v146, 16, v39
    v_and_b32 v147, 0xffff0000, v39
    v_add_f32 v125, v125, v146
    v_add_f32 v127, v127, v147
    v_fmac_f32 v129, v146, v146
    v_fmac_f32 v131, v147, v147
    s_waitcnt lgkmcnt(7)
    v_lshlrev_b32 v140, 16, v40
    v_and_b32 v141, 0xffff0000, v40
    v_add_f32 v124, v124, v140
    v_add_f32 v126, v126, v141
    v_fmac_f32 v128, v140, v140
    v_fmac_f32 v130, v141, v141
    v_lshlrev_b32 v142, 16, v41
    v_and_b32 v143, 0xffff0000, v41
    v_add_f32 v125, v125, v142
    v_add_f32 v127, v127, v143
    v_fmac_f32 v129, v142, v142
    v_fmac_f32 v131, v143, v143
    v_lshlrev_b32 v144, 16, v42
    v_and_b32 v145, 0xffff0000, v42
    v_add_f32 v124, v124, v144
    v_add_f32 v126, v126, v145
    v_fmac_f32 v128, v144, v144
    v_fmac_f32 v130, v145, v145
    v_lshlrev_b32 v146, 16, v43
    v_and_b32 v147, 0xffff0000, v43
    v_add_f32 v125, v125, v146
    v_add_f32 v127, v127, v147
    v_fmac_f32 v129, v146, v146
    v_fmac_f32 v131, v147, v147
    s_waitcnt lgkmcnt(6)
    v_lshlrev_b32 v140, 16, v44
    v_and_b32 v141, 0xffff0000, v44
    v_add_f32 v124, v124, v140
    v_add_f32 v126, v126, v141
    v_fmac_f32 v128, v140, v140
    v_fmac_f32 v130, v141, v141
    v_lshlrev_b32 v142, 16, v45
    v_and_b32 v143, 0xffff0000, v45
    v_add_f32 v125, v125, v142
    v_add_f32 v127, v127, v143
    v_fmac_f32 v129, v142, v142
    v_fmac_f32 v131, v143, v143
    v_lshlrev_b32 v144, 16, v46
    v_and_b32 v145, 0xffff0000, v46
    v_add_f32 v124, v124, v144
    v_add_f32 v126, v126, v145
    v_fmac_f32 v128, v144, v144
    v_fmac_f32 v130, v145, v145
    v_lshlrev_b32 v146, 16, v47
    v_and_b32 v147, 0xffff0000, v47
    v_add_f32 v125, v125, v146
    v_add_f32 v127, v127, v147
    v_fmac_f32 v129, v146, v146
    v_fmac_f32 v131, v147, v147
    s_waitcnt lgkmcnt(0)
    v_mfma_f32_32x32x16_bf16 v[64:79], v[132:135], v[48:51], v[64:79]
    v_mfma_f32_32x32x16_bf16 v[80:95], v[132:135], v[52:55], v[80:95]
    v_mfma_f32_32x32x16_bf16 v[96:111], v[132:135], v[56:59], v[96:111]
    s_add_u32 s50, s50, 1
    s_cmp_lt_u32 s50, 8
    s_cbranch_scc1 K1_SLOOP
    v_add_f32 v16, v124, v125
    v_add_f32 v17, v126, v127
    v_add_f32 v18, v128, v129
    v_add_f32 v19, v130, v131
    v_add_f32 v16, v16, v17
    v_add_f32 v18, v18, v19
    v_mov_b32 v17, v16
    s_nop 1
    v_permlane32_swap_b32 v16, v17
    s_nop 1
    v_add_f32 v16, v16, v17
    v_mov_b32 v19, v18
    s_nop 1
    v_permlane32_swap_b32 v18, v19
    s_nop 1
    v_add_f32 v18, v18, v19
    v_mul_f32 v16, 0x3b000000, v16
    v_mul_f32 v18, 0x3b000000, v18
    v_fma_f32 v18, -v16, v16, v18
    v_max_f32 v18, 0, v18
    v_cvt_pk_bf16_f32 v16, v16, v16
    v_lshlrev_b32 v16, 16, v16
    v_cvt_pk_bf16_f32 v18, v18, v18
    v_lshlrev_b32 v18, 16, v18
    v_add_f32 v18, 0x3727c5ac, v18
    v_cvt_pk_bf16_f32 v18, v18, v18
    v_lshlrev_b32 v18, 16, v18
    v_sqrt_f32 v18, v18
    s_nop 0
    v_cvt_pk_bf16_f32 v18, v18, v18
    v_lshlrev_b32 v18, 16, v18
    v_rcp_f32 v18, v18
    v_lshlrev_b32 v7, 2, v3
    v_add_u32 v9, s34, v7
    ds_write_b32 v9, v18
    ds_write_b32 v9, v16 offset:2048
    s_mul_i32 s35, s21, 384
    s_add_u32 s35, s35, 115200
    v_add_u32 v8, s35, v7
    ds_write_b32 v8, v64 offset:0
    ds_write_b32 v8, v80 offset:128
    ds_write_b32 v8, v96 offset:256
    s_waitcnt lgkmcnt(0)
    s_barrier
    s_branch K1_END
K1_COMPUTE:
    v_cmp_eq_u32 vcc, 0, v4
    s_waitcnt lgkmcnt(0)
    s_mov_b32 s24, s8
    s_mov_b32 s25, s9
    s_mov_b32 s26, 0xe00000
    s_mov_b32 s27, 0x00020000
    s_cmp_lt_u32 s3, 10
    s_cbranch_scc1 K1_P0
    s_cmp_eq_u32 s3, 10
    s_cbranch_scc1 K1_P1
    s_branch K1_P2
K1_P0:
    s_mov_b32 s50, 0
K1_P0_LOOP:
    s_and_b32 s51, s50, 3
    s_lshl_b32 s52, s51, 14
    s_mul_i32 s53, s51, 12288
    v_add_u32 v124, s52, v120
    v_add_u32 v125, s52, v121
    v_add_u32 v126, s52, v122
    v_add_u32 v127, s52, v123
    v_add_u32 v14, s53, v13
    s_barrier
    ds_read_b128 v[112:115], v124
    ds_read_b64_tr_b16 v[32:33], v14 offset:0
    ds_read_b64_tr_b16 v[34:35], v14 offset:768
    ds_read_b64_tr_b16 v[36:37], v14 offset:64
    ds_read_b64_tr_b16 v[38:39], v14 offset:832
    ds_read_b64_tr_b16 v[40:41], v14 offset:128
    ds_read_b64_tr_b16 v[42:43], v14 offset:896
    ds_read_b128 v[116:119], v125
    ds_read_b64_tr_b16 v[44:45], v14 offset:3072
    ds_read_b64_tr_b16 v[46:47], v14 offset:3840
    ds_read_b64_tr_b16 v[48:49], v14 offset:3136
    ds_read_b64_tr_b16 v[50:51], v14 offset:3904
    ds_read_b64_tr_b16 v[52:53], v14 offset:3200
    ds_read_b64_tr_b16 v[54:55], v14 offset:3968
    s_waitcnt lgkmcnt(7)
    v_mfma_f32_32x32x16_bf16 v[64:79], v[32:35], v[112:115], v[64:79]
    v_mfma_f32_32x32x16_bf16 v[80:95], v[36:39], v[112:115], v[80:95]
    v_mfma_f32_32x32x16_bf16 v[96:111], v[40:43], v[112:115], v[96:111]
    ds_read_b128 v[112:115], v126
    ds_read_b64_tr_b16 v[32:33], v14 offset:6144
    ds_read_b64_tr_b16 v[34:35], v14 offset:6912
    ds_read_b64_tr_b16 v[36:37], v14 offset:6208
    ds_read_b64_tr_b16 v[38:39], v14 offset:6976
    ds_read_b64_tr_b16 v[40:41], v14 offset:6272
    ds_read_b64_tr_b16 v[42:43], v14 offset:7040
    s_waitcnt lgkmcnt(7)
    v_mfma_f32_32x32x16_bf16 v[64:79], v[44:47], v[116:119], v[64:79]
    v_mfma_f32_32x32x16_bf16 v[80:95], v[48:51], v[116:119], v[80:95]
    v_mfma_f32_32x32x16_bf16 v[96:111], v[52:55], v[116:119], v[96:111]
    ds_read_b128 v[116:119], v127
    ds_read_b64_tr_b16 v[44:45], v14 offset:9216
    ds_read_b64_tr_b16 v[46:47], v14 offset:9984
    ds_read_b64_tr_b16 v[48:49], v14 offset:9280
    ds_read_b64_tr_b16 v[50:51], v14 offset:10048
    ds_read_b64_tr_b16 v[52:53], v14 offset:9344
    ds_read_b64_tr_b16 v[54:55], v14 offset:10112
    s_waitcnt lgkmcnt(7)
    v_mfma_f32_32x32x16_bf16 v[64:79], v[32:35], v[112:115], v[64:79]
    v_mfma_f32_32x32x16_bf16 v[80:95], v[36:39], v[112:115], v[80:95]
    v_mfma_f32_32x32x16_bf16 v[96:111], v[40:43], v[112:115], v[96:111]
    s_waitcnt lgkmcnt(0)
    v_mfma_f32_32x32x16_bf16 v[64:79], v[44:47], v[116:119], v[64:79]
    v_mfma_f32_32x32x16_bf16 v[80:95], v[48:51], v[116:119], v[80:95]
    v_mfma_f32_32x32x16_bf16 v[96:111], v[52:55], v[116:119], v[96:111]
    s_add_u32 s50, s50, 1
    s_cmp_lt_u32 s50, 8
    s_cbranch_scc1 K1_P0_LOOP
    v_lshlrev_b32 v7, 2, v3
    v_add_u32 v9, s34, v7
    v_add_u32 v7, 115200, v7
    s_barrier
    ds_read_b32 v128, v7 offset:0
    ds_read_b32 v129, v7 offset:384
    ds_read_b32 v130, v7 offset:768
    ds_read_b32 v131, v7 offset:1152
    ds_read_b32 v132, v7 offset:128
    ds_read_b32 v133, v7 offset:512
    ds_read_b32 v134, v7 offset:896
    ds_read_b32 v135, v7 offset:1280
    ds_read_b32 v136, v7 offset:256
    ds_read_b32 v137, v7 offset:640
    ds_read_b32 v138, v7 offset:1024
    ds_read_b32 v139, v7 offset:1408
    ds_read_b32 v18, v9
    ds_read_b32 v16, v9 offset:2048
    s_waitcnt lgkmcnt(0)
    v_add_f32 v128, v128, v129
    v_add_f32 v130, v130, v131
    v_add_f32 v20, v128, v130
    v_add_f32 v132, v132, v133
    v_add_f32 v134, v134, v135
    v_add_f32 v21, v132, v134
    v_add_f32 v136, v136, v137
    v_add_f32 v138, v138, v139
    v_add_f32 v22, v136, v138
    v_sub_f32 v17, 0, v16
    v_cvt_pk_bf16_f32 v24, v17, v17
    v_cndmask_b32 v24, 0, v24, vcc
    v_mov_b32 v25, 0
    v_mov_b32 v26, 0
    v_mov_b32 v27, 0
    v_cvt_pk_bf16_f32 v56, v20, v20
    v_lshlrev_b32 v56, 16, v56
    v_sub_f32 v57, v20, v56
    v_cvt_pk_bf16_f32 v28, v56, v57
    v_cndmask_b32 v28, 0, v28, vcc
    v_mov_b32 v29, 0
    v_mov_b32 v30, 0
    v_mov_b32 v31, 0
    s_nop 1
    v_mfma_f32_32x32x16_bf16 v[64:79], v[28:31], v[24:27], v[64:79]
    s_nop 3
    v_cvt_pk_bf16_f32 v56, v21, v21
    v_lshlrev_b32 v56, 16, v56
    v_sub_f32 v57, v21, v56
    v_cvt_pk_bf16_f32 v28, v56, v57
    v_cndmask_b32 v28, 0, v28, vcc
    v_mov_b32 v29, 0
    v_mov_b32 v30, 0
    v_mov_b32 v31, 0
    s_nop 1
    v_mfma_f32_32x32x16_bf16 v[80:95], v[28:31], v[24:27], v[80:95]
    s_nop 3
    v_cvt_pk_bf16_f32 v56, v22, v22
    v_lshlrev_b32 v56, 16, v56
    v_sub_f32 v57, v22, v56
    v_cvt_pk_bf16_f32 v28, v56, v57
    v_cndmask_b32 v28, 0, v28, vcc
    v_mov_b32 v29, 0
    v_mov_b32 v30, 0
    v_mov_b32 v31, 0
    s_nop 1
    v_mfma_f32_32x32x16_bf16 v[96:111], v[28:31], v[24:27], v[96:111]
    s_nop 3
    s_nop 15
    s_lshr_b32 s36, s22, 5
    s_mul_i32 s40, s3, 96
    s_add_u32 s40, s40, 0
    s_lshr_b32 s41, s40, 9
    s_and_b32 s42, s40, 511
    s_lshr_b32 s42, s42, 4
    s_cmp_eq_u32 s41, 0
    s_cselect_b32 s43, 0x3eb8aa3b, 1.0
    v_mul_f32 v56, s43, v18
    v_mul_f32 v64, v64, v56
    v_mul_f32 v65, v65, v56
    v_mul_f32 v66, v66, v56
    v_mul_f32 v67, v67, v56
    v_mul_f32 v68, v68, v56
    v_mul_f32 v69, v69, v56
    v_mul_f32 v70, v70, v56
    v_mul_f32 v71, v71, v56
    v_mul_f32 v72, v72, v56
    v_mul_f32 v73, v73, v56
    v_mul_f32 v74, v74, v56
    v_mul_f32 v75, v75, v56
    v_mul_f32 v76, v76, v56
    v_mul_f32 v77, v77, v56
    v_mul_f32 v78, v78, v56
    v_mul_f32 v79, v79, v56
    s_lshl_b32 s44, s41, 21
    s_lshl_b32 s45, s42, 16
    s_add_u32 s44, s44, s45
    s_lshl_b32 s45, s36, 10
    s_add_u32 s44, s44, s45
    s_add_u32 s45, s44, 0x10000
    v_lshlrev_b32 v57, 9, v4
    v_lshl_add_u32 v57, v3, 4, v57
    v_cvt_pk_bf16_f32 v32, v64, v65
    v_cvt_pk_bf16_f32 v33, v66, v67
    v_cvt_pk_bf16_f32 v34, v68, v69
    v_cvt_pk_bf16_f32 v35, v70, v71
    v_cvt_pk_bf16_f32 v36, v72, v73
    v_cvt_pk_bf16_f32 v37, v74, v75
    v_cvt_pk_bf16_f32 v38, v76, v77
    v_cvt_pk_bf16_f32 v39, v78, v79
    buffer_store_dwordx4 v[32:35], v57, s[24:27], s44 offen
    buffer_store_dwordx4 v[36:39], v57, s[24:27], s45 offen
    s_cmp_eq_u32 s41, 1
    s_cbranch_scc0 K1_P0_NK0
    v_mul_f32 v58, v64, v64
    v_mul_f32 v59, v72, v72
    v_fmac_f32 v58, v65, v65
    v_fmac_f32 v59, v73, v73
    v_fmac_f32 v58, v66, v66
    v_fmac_f32 v59, v74, v74
    v_fmac_f32 v58, v67, v67
    v_fmac_f32 v59, v75, v75
    v_fmac_f32 v58, v68, v68
    v_fmac_f32 v59, v76, v76
    v_fmac_f32 v58, v69, v69
    v_fmac_f32 v59, v77, v77
    v_fmac_f32 v58, v70, v70
    v_fmac_f32 v59, v78, v78
    v_fmac_f32 v58, v71, v71
    v_fmac_f32 v59, v79, v79
    v_mov_b32 v60, v58
    s_nop 1
    v_permlane32_swap_b32 v58, v60
    s_nop 1
    v_add_f32 v58, v58, v60
    v_mov_b32 v60, v59
    s_nop 1
    v_permlane32_swap_b32 v59, v60
    s_nop 1
    v_add_f32 v59, v59, v60
    v_add_u32 v60, s22, v3
    v_lshlrev_b32 v60, 2, v60
    s_lshl_b32 s46, s42, 13
    s_add_u32 s46, s46, 0xc00000
    s_add_u32 s47, s46, 8192
    buffer_store_dword v58, v60, s[24:27], s46 offen
    buffer_store_dword v59, v60, s[24:27], s47 offen
K1_P0_NK0:
    s_nop 1
    s_mul_i32 s40, s3, 96
    s_add_u32 s40, s40, 32
    s_lshr_b32 s41, s40, 9
    s_and_b32 s42, s40, 511
    s_lshr_b32 s42, s42, 4
    s_cmp_eq_u32 s41, 0
    s_cselect_b32 s43, 0x3eb8aa3b, 1.0
    v_mul_f32 v56, s43, v18
    v_mul_f32 v80, v80, v56
    v_mul_f32 v81, v81, v56
    v_mul_f32 v82, v82, v56
    v_mul_f32 v83, v83, v56
    v_mul_f32 v84, v84, v56
    v_mul_f32 v85, v85, v56
    v_mul_f32 v86, v86, v56
    v_mul_f32 v87, v87, v56
    v_mul_f32 v88, v88, v56
    v_mul_f32 v89, v89, v56
    v_mul_f32 v90, v90, v56
    v_mul_f32 v91, v91, v56
    v_mul_f32 v92, v92, v56
    v_mul_f32 v93, v93, v56
    v_mul_f32 v94, v94, v56
    v_mul_f32 v95, v95, v56
    s_lshl_b32 s44, s41, 21
    s_lshl_b32 s45, s42, 16
    s_add_u32 s44, s44, s45
    s_lshl_b32 s45, s36, 10
    s_add_u32 s44, s44, s45
    s_add_u32 s45, s44, 0x10000
    v_lshlrev_b32 v57, 9, v4
    v_lshl_add_u32 v57, v3, 4, v57
    v_cvt_pk_bf16_f32 v32, v80, v81
    v_cvt_pk_bf16_f32 v33, v82, v83
    v_cvt_pk_bf16_f32 v34, v84, v85
    v_cvt_pk_bf16_f32 v35, v86, v87
    v_cvt_pk_bf16_f32 v36, v88, v89
    v_cvt_pk_bf16_f32 v37, v90, v91
    v_cvt_pk_bf16_f32 v38, v92, v93
    v_cvt_pk_bf16_f32 v39, v94, v95
    buffer_store_dwordx4 v[32:35], v57, s[24:27], s44 offen
    buffer_store_dwordx4 v[36:39], v57, s[24:27], s45 offen
    s_cmp_eq_u32 s41, 1
    s_cbranch_scc0 K1_P0_NK1
    v_mul_f32 v58, v80, v80
    v_mul_f32 v59, v88, v88
    v_fmac_f32 v58, v81, v81
    v_fmac_f32 v59, v89, v89
    v_fmac_f32 v58, v82, v82
    v_fmac_f32 v59, v90, v90
    v_fmac_f32 v58, v83, v83
    v_fmac_f32 v59, v91, v91
    v_fmac_f32 v58, v84, v84
    v_fmac_f32 v59, v92, v92
    v_fmac_f32 v58, v85, v85
    v_fmac_f32 v59, v93, v93
    v_fmac_f32 v58, v86, v86
    v_fmac_f32 v59, v94, v94
    v_fmac_f32 v58, v87, v87
    v_fmac_f32 v59, v95, v95
    v_mov_b32 v60, v58
    s_nop 1
    v_permlane32_swap_b32 v58, v60
    s_nop 1
    v_add_f32 v58, v58, v60
    v_mov_b32 v60, v59
    s_nop 1
    v_permlane32_swap_b32 v59, v60
    s_nop 1
    v_add_f32 v59, v59, v60
    v_add_u32 v60, s22, v3
    v_lshlrev_b32 v60, 2, v60
    s_lshl_b32 s46, s42, 13
    s_add_u32 s46, s46, 0xc00000
    s_add_u32 s47, s46, 8192
    buffer_store_dword v58, v60, s[24:27], s46 offen
    buffer_store_dword v59, v60, s[24:27], s47 offen
K1_P0_NK1:
    s_nop 1
    s_mul_i32 s40, s3, 96
    s_add_u32 s40, s40, 64
    s_lshr_b32 s41, s40, 9
    s_and_b32 s42, s40, 511
    s_lshr_b32 s42, s42, 4
    s_cmp_eq_u32 s41, 0
    s_cselect_b32 s43, 0x3eb8aa3b, 1.0
    v_mul_f32 v56, s43, v18
    v_mul_f32 v96, v96, v56
    v_mul_f32 v97, v97, v56
    v_mul_f32 v98, v98, v56
    v_mul_f32 v99, v99, v56
    v_mul_f32 v100, v100, v56
    v_mul_f32 v101, v101, v56
    v_mul_f32 v102, v102, v56
    v_mul_f32 v103, v103, v56
    v_mul_f32 v104, v104, v56
    v_mul_f32 v105, v105, v56
    v_mul_f32 v106, v106, v56
    v_mul_f32 v107, v107, v56
    v_mul_f32 v108, v108, v56
    v_mul_f32 v109, v109, v56
    v_mul_f32 v110, v110, v56
    v_mul_f32 v111, v111, v56
    s_lshl_b32 s44, s41, 21
    s_lshl_b32 s45, s42, 16
    s_add_u32 s44, s44, s45
    s_lshl_b32 s45, s36, 10
    s_add_u32 s44, s44, s45
    s_add_u32 s45, s44, 0x10000
    v_lshlrev_b32 v57, 9, v4
    v_lshl_add_u32 v57, v3, 4, v57
    v_cvt_pk_bf16_f32 v32, v96, v97
    v_cvt_pk_bf16_f32 v33, v98, v99
    v_cvt_pk_bf16_f32 v34, v100, v101
    v_cvt_pk_bf16_f32 v35, v102, v103
    v_cvt_pk_bf16_f32 v36, v104, v105
    v_cvt_pk_bf16_f32 v37, v106, v107
    v_cvt_pk_bf16_f32 v38, v108, v109
    v_cvt_pk_bf16_f32 v39, v110, v111
    buffer_store_dwordx4 v[32:35], v57, s[24:27], s44 offen
    buffer_store_dwordx4 v[36:39], v57, s[24:27], s45 offen
    s_cmp_eq_u32 s41, 1
    s_cbranch_scc0 K1_P0_NK2
    v_mul_f32 v58, v96, v96
    v_mul_f32 v59, v104, v104
    v_fmac_f32 v58, v97, v97
    v_fmac_f32 v59, v105, v105
    v_fmac_f32 v58, v98, v98
    v_fmac_f32 v59, v106, v106
    v_fmac_f32 v58, v99, v99
    v_fmac_f32 v59, v107, v107
    v_fmac_f32 v58, v100, v100
    v_fmac_f32 v59, v108, v108
    v_fmac_f32 v58, v101, v101
    v_fmac_f32 v59, v109, v109
    v_fmac_f32 v58, v102, v102
    v_fmac_f32 v59, v110, v110
    v_fmac_f32 v58, v103, v103
    v_fmac_f32 v59, v111, v111
    v_mov_b32 v60, v58
    s_nop 1
    v_permlane32_swap_b32 v58, v60
    s_nop 1
    v_add_f32 v58, v58, v60
    v_mov_b32 v60, v59
    s_nop 1
    v_permlane32_swap_b32 v59, v60
    s_nop 1
    v_add_f32 v59, v59, v60
    v_add_u32 v60, s22, v3
    v_lshlrev_b32 v60, 2, v60
    s_lshl_b32 s46, s42, 13
    s_add_u32 s46, s46, 0xc00000
    s_add_u32 s47, s46, 8192
    buffer_store_dword v58, v60, s[24:27], s46 offen
    buffer_store_dword v59, v60, s[24:27], s47 offen
K1_P0_NK2:
    s_nop 1
    s_branch K1_END
K1_P1:
    s_mov_b32 s50, 0
K1_P1_LOOP:
    s_and_b32 s51, s50, 3
    s_lshl_b32 s52, s51, 14
    s_mul_i32 s53, s51, 12288
    v_add_u32 v124, s52, v120
    v_add_u32 v125, s52, v121
    v_add_u32 v126, s52, v122
    v_add_u32 v127, s52, v123
    v_add_u32 v14, s53, v13
    s_barrier
    ds_read_b128 v[112:115], v124
    ds_read_b64_tr_b16 v[32:33], v14 offset:0
    ds_read_b64_tr_b16 v[34:35], v14 offset:768
    ds_read_b64_tr_b16 v[36:37], v14 offset:64
    ds_read_b64_tr_b16 v[38:39], v14 offset:832
    ds_read_b64_tr_b16 v[40:41], v14 offset:128
    ds_read_b64_tr_b16 v[42:43], v14 offset:896
    ds_read_b128 v[116:119], v125
    ds_read_b64_tr_b16 v[44:45], v14 offset:3072
    ds_read_b64_tr_b16 v[46:47], v14 offset:3840
    ds_read_b64_tr_b16 v[48:49], v14 offset:3136
    ds_read_b64_tr_b16 v[50:51], v14 offset:3904
    ds_read_b64_tr_b16 v[52:53], v14 offset:3200
    ds_read_b64_tr_b16 v[54:55], v14 offset:3968
    s_waitcnt lgkmcnt(7)
    v_mfma_f32_32x32x16_bf16 v[64:79], v[32:35], v[112:115], v[64:79]
    v_mfma_f32_32x32x16_bf16 v[80:95], v[36:39], v[112:115], v[80:95]
    v_mfma_f32_32x32x16_bf16 v[96:111], v[112:115], v[40:43], v[96:111]
    ds_read_b128 v[112:115], v126
    ds_read_b64_tr_b16 v[32:33], v14 offset:6144
    ds_read_b64_tr_b16 v[34:35], v14 offset:6912
    ds_read_b64_tr_b16 v[36:37], v14 offset:6208
    ds_read_b64_tr_b16 v[38:39], v14 offset:6976
    ds_read_b64_tr_b16 v[40:41], v14 offset:6272
    ds_read_b64_tr_b16 v[42:43], v14 offset:7040
    s_waitcnt lgkmcnt(7)
    v_mfma_f32_32x32x16_bf16 v[64:79], v[44:47], v[116:119], v[64:79]
    v_mfma_f32_32x32x16_bf16 v[80:95], v[48:51], v[116:119], v[80:95]
    v_mfma_f32_32x32x16_bf16 v[96:111], v[116:119], v[52:55], v[96:111]
    ds_read_b128 v[116:119], v127
    ds_read_b64_tr_b16 v[44:45], v14 offset:9216
    ds_read_b64_tr_b16 v[46:47], v14 offset:9984
    ds_read_b64_tr_b16 v[48:49], v14 offset:9280
    ds_read_b64_tr_b16 v[50:51], v14 offset:10048
    ds_read_b64_tr_b16 v[52:53], v14 offset:9344
    ds_read_b64_tr_b16 v[54:55], v14 offset:10112
    s_waitcnt lgkmcnt(7)
    v_mfma_f32_32x32x16_bf16 v[64:79], v[32:35], v[112:115], v[64:79]
    v_mfma_f32_32x32x16_bf16 v[80:95], v[36:39], v[112:115], v[80:95]
    v_mfma_f32_32x32x16_bf16 v[96:111], v[112:115], v[40:43], v[96:111]
    s_waitcnt lgkmcnt(0)
    v_mfma_f32_32x32x16_bf16 v[64:79], v[44:47], v[116:119], v[64:79]
    v_mfma_f32_32x32x16_bf16 v[80:95], v[48:51], v[116:119], v[80:95]
    v_mfma_f32_32x32x16_bf16 v[96:111], v[116:119], v[52:55], v[96:111]
    s_add_u32 s50, s50, 1
    s_cmp_lt_u32 s50, 8
    s_cbranch_scc1 K1_P1_LOOP
    v_lshlrev_b32 v7, 2, v3
    v_add_u32 v9, s34, v7
    v_add_u32 v7, 115200, v7
    s_barrier
    ds_read_b32 v128, v7 offset:0
    ds_read_b32 v129, v7 offset:384
    ds_read_b32 v130, v7 offset:768
    ds_read_b32 v131, v7 offset:1152
    ds_read_b32 v132, v7 offset:128
    ds_read_b32 v133, v7 offset:512
    ds_read_b32 v134, v7 offset:896
    ds_read_b32 v135, v7 offset:1280
    ds_read_b32 v136, v7 offset:256
    ds_read_b32 v137, v7 offset:640
    ds_read_b32 v138, v7 offset:1024
    ds_read_b32 v139, v7 offset:1408
    ds_read_b32 v18, v9
    ds_read_b32 v16, v9 offset:2048
    s_waitcnt lgkmcnt(0)
    v_add_f32 v128, v128, v129
    v_add_f32 v130, v130, v131
    v_add_f32 v20, v128, v130
    v_add_f32 v132, v132, v133
    v_add_f32 v134, v134, v135
    v_add_f32 v21, v132, v134
    v_add_f32 v136, v136, v137
    v_add_f32 v138, v138, v139
    v_add_f32 v22, v136, v138
    v_sub_f32 v17, 0, v16
    v_cvt_pk_bf16_f32 v24, v17, v17
    v_cndmask_b32 v24, 0, v24, vcc
    v_mov_b32 v25, 0
    v_mov_b32 v26, 0
    v_mov_b32 v27, 0
    v_cvt_pk_bf16_f32 v56, v20, v20
    v_lshlrev_b32 v56, 16, v56
    v_sub_f32 v57, v20, v56
    v_cvt_pk_bf16_f32 v28, v56, v57
    v_cndmask_b32 v28, 0, v28, vcc
    v_mov_b32 v29, 0
    v_mov_b32 v30, 0
    v_mov_b32 v31, 0
    s_nop 1
    v_mfma_f32_32x32x16_bf16 v[64:79], v[28:31], v[24:27], v[64:79]
    s_nop 3
    v_cvt_pk_bf16_f32 v56, v21, v21
    v_lshlrev_b32 v56, 16, v56
    v_sub_f32 v57, v21, v56
    v_cvt_pk_bf16_f32 v28, v56, v57
    v_cndmask_b32 v28, 0, v28, vcc
    v_mov_b32 v29, 0
    v_mov_b32 v30, 0
    v_mov_b32 v31, 0
    s_nop 1
    v_mfma_f32_32x32x16_bf16 v[80:95], v[28:31], v[24:27], v[80:95]
    s_nop 3
    v_cvt_pk_bf16_f32 v56, v22, v22
    v_lshlrev_b32 v56, 16, v56
    v_sub_f32 v57, v22, v56
    v_cvt_pk_bf16_f32 v28, v56, v57
    v_cndmask_b32 v28, 0, v28, vcc
    v_mov_b32 v29, 0
    v_mov_b32 v30, 0
    v_mov_b32 v31, 0
    s_nop 1
    v_mfma_f32_32x32x16_bf16 v[96:111], v[24:27], v[28:31], v[96:111]
    s_nop 3
    s_nop 15
    s_lshr_b32 s36, s22, 5
    s_mul_i32 s40, s3, 96
    s_add_u32 s40, s40, 0
    s_lshr_b32 s41, s40, 9
    s_and_b32 s42, s40, 511
    s_lshr_b32 s42, s42, 4
    s_cmp_eq_u32 s41, 0
    s_cselect_b32 s43, 0x3eb8aa3b, 1.0
    v_mul_f32 v56, s43, v18
    v_mul_f32 v64, v64, v56
    v_mul_f32 v65, v65, v56
    v_mul_f32 v66, v66, v56
    v_mul_f32 v67, v67, v56
    v_mul_f32 v68, v68, v56
    v_mul_f32 v69, v69, v56
    v_mul_f32 v70, v70, v56
    v_mul_f32 v71, v71, v56
    v_mul_f32 v72, v72, v56
    v_mul_f32 v73, v73, v56
    v_mul_f32 v74, v74, v56
    v_mul_f32 v75, v75, v56
    v_mul_f32 v76, v76, v56
    v_mul_f32 v77, v77, v56
    v_mul_f32 v78, v78, v56
    v_mul_f32 v79, v79, v56
    s_lshl_b32 s44, s41, 21
    s_lshl_b32 s45, s42, 16
    s_add_u32 s44, s44, s45
    s_lshl_b32 s45, s36, 10
    s_add_u32 s44, s44, s45
    s_add_u32 s45, s44, 0x10000
    v_lshlrev_b32 v57, 9, v4
    v_lshl_add_u32 v57, v3, 4, v57
    v_cvt_pk_bf16_f32 v32, v64, v65
    v_cvt_pk_bf16_f32 v33, v66, v67
    v_cvt_pk_bf16_f32 v34, v68, v69
    v_cvt_pk_bf16_f32 v35, v70, v71
    v_cvt_pk_bf16_f32 v36, v72, v73
    v_cvt_pk_bf16_f32 v37, v74, v75
    v_cvt_pk_bf16_f32 v38, v76, v77
    v_cvt_pk_bf16_f32 v39, v78, v79
    buffer_store_dwordx4 v[32:35], v57, s[24:27], s44 offen
    buffer_store_dwordx4 v[36:39], v57, s[24:27], s45 offen
    s_cmp_eq_u32 s41, 1
    s_cbranch_scc0 K1_P1_NK0
    v_mul_f32 v58, v64, v64
    v_mul_f32 v59, v72, v72
    v_fmac_f32 v58, v65, v65
    v_fmac_f32 v59, v73, v73
    v_fmac_f32 v58, v66, v66
    v_fmac_f32 v59, v74, v74
    v_fmac_f32 v58, v67, v67
    v_fmac_f32 v59, v75, v75
    v_fmac_f32 v58, v68, v68
    v_fmac_f32 v59, v76, v76
    v_fmac_f32 v58, v69, v69
    v_fmac_f32 v59, v77, v77
    v_fmac_f32 v58, v70, v70
    v_fmac_f32 v59, v78, v78
    v_fmac_f32 v58, v71, v71
    v_fmac_f32 v59, v79, v79
    v_mov_b32 v60, v58
    s_nop 1
    v_permlane32_swap_b32 v58, v60
    s_nop 1
    v_add_f32 v58, v58, v60
    v_mov_b32 v60, v59
    s_nop 1
    v_permlane32_swap_b32 v59, v60
    s_nop 1
    v_add_f32 v59, v59, v60
    v_add_u32 v60, s22, v3
    v_lshlrev_b32 v60, 2, v60
    s_lshl_b32 s46, s42, 13
    s_add_u32 s46, s46, 0xc00000
    s_add_u32 s47, s46, 8192
    buffer_store_dword v58, v60, s[24:27], s46 offen
    buffer_store_dword v59, v60, s[24:27], s47 offen
K1_P1_NK0:
    s_nop 1
    s_mul_i32 s40, s3, 96
    s_add_u32 s40, s40, 32
    s_lshr_b32 s41, s40, 9
    s_and_b32 s42, s40, 511
    s_lshr_b32 s42, s42, 4
    s_cmp_eq_u32 s41, 0
    s_cselect_b32 s43, 0x3eb8aa3b, 1.0
    v_mul_f32 v56, s43, v18
    v_mul_f32 v80, v80, v56
    v_mul_f32 v81, v81, v56
    v_mul_f32 v82, v82, v56
    v_mul_f32 v83, v83, v56
    v_mul_f32 v84, v84, v56
    v_mul_f32 v85, v85, v56
    v_mul_f32 v86, v86, v56
    v_mul_f32 v87, v87, v56
    v_mul_f32 v88, v88, v56
    v_mul_f32 v89, v89, v56
    v_mul_f32 v90, v90, v56
    v_mul_f32 v91, v91, v56
    v_mul_f32 v92, v92, v56
    v_mul_f32 v93, v93, v56
    v_mul_f32 v94, v94, v56
    v_mul_f32 v95, v95, v56
    s_lshl_b32 s44, s41, 21
    s_lshl_b32 s45, s42, 16
    s_add_u32 s44, s44, s45
    s_lshl_b32 s45, s36, 10
    s_add_u32 s44, s44, s45
    s_add_u32 s45, s44, 0x10000
    v_lshlrev_b32 v57, 9, v4
    v_lshl_add_u32 v57, v3, 4, v57
    v_cvt_pk_bf16_f32 v32, v80, v81
    v_cvt_pk_bf16_f32 v33, v82, v83
    v_cvt_pk_bf16_f32 v34, v84, v85
    v_cvt_pk_bf16_f32 v35, v86, v87
    v_cvt_pk_bf16_f32 v36, v88, v89
    v_cvt_pk_bf16_f32 v37, v90, v91
    v_cvt_pk_bf16_f32 v38, v92, v93
    v_cvt_pk_bf16_f32 v39, v94, v95
    buffer_store_dwordx4 v[32:35], v57, s[24:27], s44 offen
    buffer_store_dwordx4 v[36:39], v57, s[24:27], s45 offen
    s_cmp_eq_u32 s41, 1
    s_cbranch_scc0 K1_P1_NK1
    v_mul_f32 v58, v80, v80
    v_mul_f32 v59, v88, v88
    v_fmac_f32 v58, v81, v81
    v_fmac_f32 v59, v89, v89
    v_fmac_f32 v58, v82, v82
    v_fmac_f32 v59, v90, v90
    v_fmac_f32 v58, v83, v83
    v_fmac_f32 v59, v91, v91
    v_fmac_f32 v58, v84, v84
    v_fmac_f32 v59, v92, v92
    v_fmac_f32 v58, v85, v85
    v_fmac_f32 v59, v93, v93
    v_fmac_f32 v58, v86, v86
    v_fmac_f32 v59, v94, v94
    v_fmac_f32 v58, v87, v87
    v_fmac_f32 v59, v95, v95
    v_mov_b32 v60, v58
    s_nop 1
    v_permlane32_swap_b32 v58, v60
    s_nop 1
    v_add_f32 v58, v58, v60
    v_mov_b32 v60, v59
    s_nop 1
    v_permlane32_swap_b32 v59, v60
    s_nop 1
    v_add_f32 v59, v59, v60
    v_add_u32 v60, s22, v3
    v_lshlrev_b32 v60, 2, v60
    s_lshl_b32 s46, s42, 13
    s_add_u32 s46, s46, 0xc00000
    s_add_u32 s47, s46, 8192
    buffer_store_dword v58, v60, s[24:27], s46 offen
    buffer_store_dword v59, v60, s[24:27], s47 offen
K1_P1_NK1:
    s_nop 1
    s_mul_i32 s40, s3, 96
    s_add_u32 s40, s40, 64
    s_lshr_b32 s41, s40, 9
    s_and_b32 s42, s40, 511
    s_lshr_b32 s42, s42, 4
    v_lshlrev_b32 v57, 4, v4
    v_add_u32 v57, s34, v57
    ds_read_b128 v[40:43], v57 offset:0
    ds_read_b128 v[44:47], v57 offset:32
    ds_read_b128 v[48:51], v57 offset:64
    ds_read_b128 v[52:55], v57 offset:96
    s_waitcnt lgkmcnt(0)
    v_mul_f32 v96, v96, v40
    v_mul_f32 v97, v97, v41
    v_mul_f32 v98, v98, v42
    v_mul_f32 v99, v99, v43
    v_mul_f32 v100, v100, v44
    v_mul_f32 v101, v101, v45
    v_mul_f32 v102, v102, v46
    v_mul_f32 v103, v103, v47
    v_mul_f32 v104, v104, v48
    v_mul_f32 v105, v105, v49
    v_mul_f32 v106, v106, v50
    v_mul_f32 v107, v107, v51
    v_mul_f32 v108, v108, v52
    v_mul_f32 v109, v109, v53
    v_mul_f32 v110, v110, v54
    v_mul_f32 v111, v111, v55
    s_lshl_b32 s45, s42, 16
    s_add_u32 s44, s45, 0x400000
    s_lshl_b32 s45, s36, 10
    s_add_u32 s44, s44, s45
    v_lshrrev_b32 v57, 4, v3
    v_lshlrev_b32 v57, 16, v57
    v_lshl_add_u32 v57, v4, 8, v57
    v_and_b32 v58, 15, v3
    v_lshl_add_u32 v57, v58, 4, v57
    v_cvt_pk_bf16_f32 v32, v96, v97
    v_cvt_pk_bf16_f32 v33, v98, v99
    v_cvt_pk_bf16_f32 v34, v100, v101
    v_cvt_pk_bf16_f32 v35, v102, v103
    v_cvt_pk_bf16_f32 v36, v104, v105
    v_cvt_pk_bf16_f32 v37, v106, v107
    v_cvt_pk_bf16_f32 v38, v108, v109
    v_cvt_pk_bf16_f32 v39, v110, v111
    buffer_store_dwordx4 v[32:35], v57, s[24:27], s44 offen
    buffer_store_dwordx4 v[36:39], v57, s[24:27], s44 offen offset:512
    s_nop 1
    s_branch K1_END
K1_P2:
    s_mov_b32 s50, 0
K1_P2_LOOP:
    s_and_b32 s51, s50, 3
    s_lshl_b32 s52, s51, 14
    s_mul_i32 s53, s51, 12288
    v_add_u32 v124, s52, v120
    v_add_u32 v125, s52, v121
    v_add_u32 v126, s52, v122
    v_add_u32 v127, s52, v123
    v_add_u32 v14, s53, v13
    s_barrier
    ds_read_b128 v[112:115], v124
    ds_read_b64_tr_b16 v[32:33], v14 offset:0
    ds_read_b64_tr_b16 v[34:35], v14 offset:768
    ds_read_b64_tr_b16 v[36:37], v14 offset:64
    ds_read_b64_tr_b16 v[38:39], v14 offset:832
    ds_read_b64_tr_b16 v[40:41], v14 offset:128
    ds_read_b64_tr_b16 v[42:43], v14 offset:896
    ds_read_b128 v[116:119], v125
    ds_read_b64_tr_b16 v[44:45], v14 offset:3072
    ds_read_b64_tr_b16 v[46:47], v14 offset:3840
    ds_read_b64_tr_b16 v[48:49], v14 offset:3136
    ds_read_b64_tr_b16 v[50:51], v14 offset:3904
    ds_read_b64_tr_b16 v[52:53], v14 offset:3200
    ds_read_b64_tr_b16 v[54:55], v14 offset:3968
    s_waitcnt lgkmcnt(7)
    v_mfma_f32_32x32x16_bf16 v[64:79], v[112:115], v[32:35], v[64:79]
    v_mfma_f32_32x32x16_bf16 v[80:95], v[112:115], v[36:39], v[80:95]
    v_mfma_f32_32x32x16_bf16 v[96:111], v[112:115], v[40:43], v[96:111]
    ds_read_b128 v[112:115], v126
    ds_read_b64_tr_b16 v[32:33], v14 offset:6144
    ds_read_b64_tr_b16 v[34:35], v14 offset:6912
    ds_read_b64_tr_b16 v[36:37], v14 offset:6208
    ds_read_b64_tr_b16 v[38:39], v14 offset:6976
    ds_read_b64_tr_b16 v[40:41], v14 offset:6272
    ds_read_b64_tr_b16 v[42:43], v14 offset:7040
    s_waitcnt lgkmcnt(7)
    v_mfma_f32_32x32x16_bf16 v[64:79], v[116:119], v[44:47], v[64:79]
    v_mfma_f32_32x32x16_bf16 v[80:95], v[116:119], v[48:51], v[80:95]
    v_mfma_f32_32x32x16_bf16 v[96:111], v[116:119], v[52:55], v[96:111]
    ds_read_b128 v[116:119], v127
    ds_read_b64_tr_b16 v[44:45], v14 offset:9216
    ds_read_b64_tr_b16 v[46:47], v14 offset:9984
    ds_read_b64_tr_b16 v[48:49], v14 offset:9280
    ds_read_b64_tr_b16 v[50:51], v14 offset:10048
    ds_read_b64_tr_b16 v[52:53], v14 offset:9344
    ds_read_b64_tr_b16 v[54:55], v14 offset:10112
    s_waitcnt lgkmcnt(7)
    v_mfma_f32_32x32x16_bf16 v[64:79], v[112:115], v[32:35], v[64:79]
    v_mfma_f32_32x32x16_bf16 v[80:95], v[112:115], v[36:39], v[80:95]
    v_mfma_f32_32x32x16_bf16 v[96:111], v[112:115], v[40:43], v[96:111]
    s_waitcnt lgkmcnt(0)
    v_mfma_f32_32x32x16_bf16 v[64:79], v[116:119], v[44:47], v[64:79]
    v_mfma_f32_32x32x16_bf16 v[80:95], v[116:119], v[48:51], v[80:95]
    v_mfma_f32_32x32x16_bf16 v[96:111], v[116:119], v[52:55], v[96:111]
    s_add_u32 s50, s50, 1
    s_cmp_lt_u32 s50, 8
    s_cbranch_scc1 K1_P2_LOOP
    v_lshlrev_b32 v7, 2, v3
    v_add_u32 v9, s34, v7
    v_add_u32 v7, 115200, v7
    s_barrier
    ds_read_b32 v128, v7 offset:0
    ds_read_b32 v129, v7 offset:384
    ds_read_b32 v130, v7 offset:768
    ds_read_b32 v131, v7 offset:1152
    ds_read_b32 v132, v7 offset:128
    ds_read_b32 v133, v7 offset:512
    ds_read_b32 v134, v7 offset:896
    ds_read_b32 v135, v7 offset:1280
    ds_read_b32 v136, v7 offset:256
    ds_read_b32 v137, v7 offset:640
    ds_read_b32 v138, v7 offset:1024
    ds_read_b32 v139, v7 offset:1408
    ds_read_b32 v18, v9
    ds_read_b32 v16, v9 offset:2048
    s_waitcnt lgkmcnt(0)
    v_add_f32 v128, v128, v129
    v_add_f32 v130, v130, v131
    v_add_f32 v20, v128, v130
    v_add_f32 v132, v132, v133
    v_add_f32 v134, v134, v135
    v_add_f32 v21, v132, v134
    v_add_f32 v136, v136, v137
    v_add_f32 v138, v138, v139
    v_add_f32 v22, v136, v138
    v_sub_f32 v17, 0, v16
    v_cvt_pk_bf16_f32 v24, v17, v17
    v_cndmask_b32 v24, 0, v24, vcc
    v_mov_b32 v25, 0
    v_mov_b32 v26, 0
    v_mov_b32 v27, 0
    v_cvt_pk_bf16_f32 v56, v20, v20
    v_lshlrev_b32 v56, 16, v56
    v_sub_f32 v57, v20, v56
    v_cvt_pk_bf16_f32 v28, v56, v57
    v_cndmask_b32 v28, 0, v28, vcc
    v_mov_b32 v29, 0
    v_mov_b32 v30, 0
    v_mov_b32 v31, 0
    s_nop 1
    v_mfma_f32_32x32x16_bf16 v[64:79], v[24:27], v[28:31], v[64:79]
    s_nop 3
    v_cvt_pk_bf16_f32 v56, v21, v21
    v_lshlrev_b32 v56, 16, v56
    v_sub_f32 v57, v21, v56
    v_cvt_pk_bf16_f32 v28, v56, v57
    v_cndmask_b32 v28, 0, v28, vcc
    v_mov_b32 v29, 0
    v_mov_b32 v30, 0
    v_mov_b32 v31, 0
    s_nop 1
    v_mfma_f32_32x32x16_bf16 v[80:95], v[24:27], v[28:31], v[80:95]
    s_nop 3
    v_cvt_pk_bf16_f32 v56, v22, v22
    v_lshlrev_b32 v56, 16, v56
    v_sub_f32 v57, v22, v56
    v_cvt_pk_bf16_f32 v28, v56, v57
    v_cndmask_b32 v28, 0, v28, vcc
    v_mov_b32 v29, 0
    v_mov_b32 v30, 0
    v_mov_b32 v31, 0
    s_nop 1
    v_mfma_f32_32x32x16_bf16 v[96:111], v[24:27], v[28:31], v[96:111]
    s_nop 3
    s_nop 15
    s_lshr_b32 s36, s22, 5
    s_mul_i32 s40, s3, 96
    s_add_u32 s40, s40, 0
    s_lshr_b32 s41, s40, 9
    s_and_b32 s42, s40, 511
    s_lshr_b32 s42, s42, 4
    v_lshlrev_b32 v57, 4, v4
    v_add_u32 v57, s34, v57
    ds_read_b128 v[40:43], v57 offset:0
    ds_read_b128 v[44:47], v57 offset:32
    ds_read_b128 v[48:51], v57 offset:64
    ds_read_b128 v[52:55], v57 offset:96
    s_waitcnt lgkmcnt(0)
    v_mul_f32 v64, v64, v40
    v_mul_f32 v65, v65, v41
    v_mul_f32 v66, v66, v42
    v_mul_f32 v67, v67, v43
    v_mul_f32 v68, v68, v44
    v_mul_f32 v69, v69, v45
    v_mul_f32 v70, v70, v46
    v_mul_f32 v71, v71, v47
    v_mul_f32 v72, v72, v48
    v_mul_f32 v73, v73, v49
    v_mul_f32 v74, v74, v50
    v_mul_f32 v75, v75, v51
    v_mul_f32 v76, v76, v52
    v_mul_f32 v77, v77, v53
    v_mul_f32 v78, v78, v54
    v_mul_f32 v79, v79, v55
    s_lshl_b32 s45, s42, 16
    s_add_u32 s44, s45, 0x400000
    s_lshl_b32 s45, s36, 10
    s_add_u32 s44, s44, s45
    v_lshrrev_b32 v57, 4, v3
    v_lshlrev_b32 v57, 16, v57
    v_lshl_add_u32 v57, v4, 8, v57
    v_and_b32 v58, 15, v3
    v_lshl_add_u32 v57, v58, 4, v57
    v_cvt_pk_bf16_f32 v32, v64, v65
    v_cvt_pk_bf16_f32 v33, v66, v67
    v_cvt_pk_bf16_f32 v34, v68, v69
    v_cvt_pk_bf16_f32 v35, v70, v71
    v_cvt_pk_bf16_f32 v36, v72, v73
    v_cvt_pk_bf16_f32 v37, v74, v75
    v_cvt_pk_bf16_f32 v38, v76, v77
    v_cvt_pk_bf16_f32 v39, v78, v79
    buffer_store_dwordx4 v[32:35], v57, s[24:27], s44 offen
    buffer_store_dwordx4 v[36:39], v57, s[24:27], s44 offen offset:512
    s_nop 1
    s_mul_i32 s40, s3, 96
    s_add_u32 s40, s40, 32
    s_lshr_b32 s41, s40, 9
    s_and_b32 s42, s40, 511
    s_lshr_b32 s42, s42, 4
    v_lshlrev_b32 v57, 4, v4
    v_add_u32 v57, s34, v57
    ds_read_b128 v[40:43], v57 offset:0
    ds_read_b128 v[44:47], v57 offset:32
    ds_read_b128 v[48:51], v57 offset:64
    ds_read_b128 v[52:55], v57 offset:96
    s_waitcnt lgkmcnt(0)
    v_mul_f32 v80, v80, v40
    v_mul_f32 v81, v81, v41
    v_mul_f32 v82, v82, v42
    v_mul_f32 v83, v83, v43
    v_mul_f32 v84, v84, v44
    v_mul_f32 v85, v85, v45
    v_mul_f32 v86, v86, v46
    v_mul_f32 v87, v87, v47
    v_mul_f32 v88, v88, v48
    v_mul_f32 v89, v89, v49
    v_mul_f32 v90, v90, v50
    v_mul_f32 v91, v91, v51
    v_mul_f32 v92, v92, v52
    v_mul_f32 v93, v93, v53
    v_mul_f32 v94, v94, v54
    v_mul_f32 v95, v95, v55
    s_lshl_b32 s45, s42, 16
    s_add_u32 s44, s45, 0x400000
    s_lshl_b32 s45, s36, 10
    s_add_u32 s44, s44, s45
    v_lshrrev_b32 v57, 4, v3
    v_lshlrev_b32 v57, 16, v57
    v_lshl_add_u32 v57, v4, 8, v57
    v_and_b32 v58, 15, v3
    v_lshl_add_u32 v57, v58, 4, v57
    v_cvt_pk_bf16_f32 v32, v80, v81
    v_cvt_pk_bf16_f32 v33, v82, v83
    v_cvt_pk_bf16_f32 v34, v84, v85
    v_cvt_pk_bf16_f32 v35, v86, v87
    v_cvt_pk_bf16_f32 v36, v88, v89
    v_cvt_pk_bf16_f32 v37, v90, v91
    v_cvt_pk_bf16_f32 v38, v92, v93
    v_cvt_pk_bf16_f32 v39, v94, v95
    buffer_store_dwordx4 v[32:35], v57, s[24:27], s44 offen
    buffer_store_dwordx4 v[36:39], v57, s[24:27], s44 offen offset:512
    s_nop 1
    s_mul_i32 s40, s3, 96
    s_add_u32 s40, s40, 64
    s_lshr_b32 s41, s40, 9
    s_and_b32 s42, s40, 511
    s_lshr_b32 s42, s42, 4
    v_lshlrev_b32 v57, 4, v4
    v_add_u32 v57, s34, v57
    ds_read_b128 v[40:43], v57 offset:0
    ds_read_b128 v[44:47], v57 offset:32
    ds_read_b128 v[48:51], v57 offset:64
    ds_read_b128 v[52:55], v57 offset:96
    s_waitcnt lgkmcnt(0)
    v_mul_f32 v96, v96, v40
    v_mul_f32 v97, v97, v41
    v_mul_f32 v98, v98, v42
    v_mul_f32 v99, v99, v43
    v_mul_f32 v100, v100, v44
    v_mul_f32 v101, v101, v45
    v_mul_f32 v102, v102, v46
    v_mul_f32 v103, v103, v47
    v_mul_f32 v104, v104, v48
    v_mul_f32 v105, v105, v49
    v_mul_f32 v106, v106, v50
    v_mul_f32 v107, v107, v51
    v_mul_f32 v108, v108, v52
    v_mul_f32 v109, v109, v53
    v_mul_f32 v110, v110, v54
    v_mul_f32 v111, v111, v55
    s_lshl_b32 s45, s42, 16
    s_add_u32 s44, s45, 0x400000
    s_lshl_b32 s45, s36, 10
    s_add_u32 s44, s44, s45
    v_lshrrev_b32 v57, 4, v3
    v_lshlrev_b32 v57, 16, v57
    v_lshl_add_u32 v57, v4, 8, v57
    v_and_b32 v58, 15, v3
    v_lshl_add_u32 v57, v58, 4, v57
    v_cvt_pk_bf16_f32 v32, v96, v97
    v_cvt_pk_bf16_f32 v33, v98, v99
    v_cvt_pk_bf16_f32 v34, v100, v101
    v_cvt_pk_bf16_f32 v35, v102, v103
    v_cvt_pk_bf16_f32 v36, v104, v105
    v_cvt_pk_bf16_f32 v37, v106, v107
    v_cvt_pk_bf16_f32 v38, v108, v109
    v_cvt_pk_bf16_f32 v39, v110, v111
    buffer_store_dwordx4 v[32:35], v57, s[24:27], s44 offen
    buffer_store_dwordx4 v[36:39], v57, s[24:27], s44 offen offset:512
    s_nop 1
    s_branch K1_END
K1_END:
    s_endpgm
.globl k2_attn_kernel
.p2align 8
.type k2_attn_kernel,@function
k2_attn_kernel:
    s_cmp_ge_u32 s2, 256
    s_cbranch_scc1 K2_END
    s_load_dwordx2 s[8:9], s[0:1], 80
    s_and_b32 s3, s2, 31
    s_lshr_b32 s20, s2, 5
    v_lshrrev_b32 v1, 6, v0
    v_and_b32 v2, 63, v0
    s_nop 0
    v_readfirstlane_b32 s21, v1
    v_and_b32 v3, 31, v2
    v_lshrrev_b32 v4, 5, v2
    s_lshl_b32 s22, s3, 16
    v_lshlrev_b32 v5, 4, v2
    s_lshl_b32 s23, s20, 3
    s_add_u32 s23, s23, s21
    s_lshl_b32 s28, s23, 10
    s_add_u32 s28, s28, s22
    v_lshlrev_b32 v6, 9, v4
    v_lshl_add_u32 v6, v3, 4, v6
    s_lshl_b32 s33, s21, 10
    s_lshl_b32 s29, s3, 13
    s_add_u32 s29, s29, 0xc00000
    s_add_u32 s29, s29, s33
    s_add_u32 s31, s22, 0x200000
    s_add_u32 s32, s22, 0x400000
    s_add_u32 s31, s31, s33
    s_add_u32 s32, s32, s33
    s_waitcnt lgkmcnt(0)
    s_mov_b32 s24, s8
    s_mov_b32 s25, s9
    s_mov_b32 s26, 0xe00000
    s_mov_b32 s27, 0x00020000
    s_cmp_eq_u32 s21, 8
    s_cbranch_scc1 K2_HELPER
    buffer_load_dwordx4 v[64:67], v5, s[24:27], s29 offen
    buffer_load_dwordx4 v[8:11], v6, s[24:27], s28 offen
    s_mov_b32 s44, 0
    s_add_u32 s34, s33, s44
    s_mov_b32 m0, s34
    s_add_u32 s35, s31, s44
    buffer_load_dwordx4 v5, s[24:27], s35 offen lds
    s_add_u32 s34, s34, 65536
    s_mov_b32 m0, s34
    s_add_u32 s35, s32, s44
    buffer_load_dwordx4 v5, s[24:27], s35 offen lds
    s_mov_b32 s44, 8192
    s_add_u32 s34, s33, s44
    s_mov_b32 m0, s34
    s_add_u32 s35, s31, s44
    buffer_load_dwordx4 v5, s[24:27], s35 offen lds
    s_add_u32 s34, s34, 65536
    s_mov_b32 m0, s34
    s_add_u32 s35, s32, s44
    buffer_load_dwordx4 v5, s[24:27], s35 offen lds
    v_lshlrev_b32 v7, 4, v0
    v_add_u32 v7, 0x20000, v7
    v_mov_b32 v24, 0x3f803f80
    v_mov_b32 v25, 0x3f803f80
    v_mov_b32 v26, 0x3f803f80
    v_mov_b32 v27, 0x3f803f80
    ds_write_b128 v7, v[24:27]
    v_and_b32 v17, 15, v3
    v_lshlrev_b32 v15, 8, v4
    v_lshl_add_u32 v15, v17, 4, v15
    v_cmp_gt_u32 vcc, 16, v3
    v_add_u32 v18, 0x10000, v15
    v_add_u32 v19, 0x20000, v15
    v_mov_b32 v16, 0x1000
    s_nop 0
    v_cndmask_b32 v21, v19, v18, vcc
    v_cndmask_b32 v16, 0, v16, vcc
    v_mov_b32 v20, v6
    s_waitcnt vmcnt(5)
    v_max3_f32 v17, v64, v65, v66
    v_max_f32 v17, v17, v67
    s_nop 1
    v_max_f32_dpp v17, v17, v17 row_ror:8 row_mask:0xf bank_mask:0xf
    s_nop 1
    v_max_f32_dpp v17, v17, v17 row_ror:4 row_mask:0xf bank_mask:0xf
    s_nop 1
    v_max_f32_dpp v17, v17, v17 row_ror:2 row_mask:0xf bank_mask:0xf
    s_nop 1
    v_max_f32_dpp v17, v17, v17 row_ror:1 row_mask:0xf bank_mask:0xf
    s_nop 1
    v_readlane_b32 s36, v17, 0
    v_readlane_b32 s37, v17, 16
    v_readlane_b32 s38, v17, 32
    v_readlane_b32 s39, v17, 48
    s_nop 1
    v_mov_b32 v17, s36
    v_max_f32 v17, s37, v17
    v_max_f32 v17, s38, v17
    v_max_f32 v17, s39, v17
    s_lshl_b32 s36, s21, 2
    s_add_u32 s36, s36, 139264
    v_mov_b32 v18, s36
    ds_write_b32 v18, v17
    s_waitcnt vmcnt(4)
    v_dot2_f32_bf16 v18, v8, v8, 0
    v_dot2_f32_bf16 v18, v9, v9, v18
    v_dot2_f32_bf16 v18, v10, v10, v18
    v_dot2_f32_bf16 v18, v11, v11, v18
    s_nop 2
    v_mov_b32 v19, v18
    s_nop 1
    v_permlane32_swap_b32 v18, v19
    s_nop 1
    v_add_f32 v18, v18, v19
    s_mov_b32 s40, 0
    s_mov_b32 s42, 10
    v_mov_b32 v19, 139264
    s_waitcnt vmcnt(2) lgkmcnt(0)
    s_barrier
    ds_read_b128 v[24:27], v19
    ds_read_b128 v[28:31], v19 offset:16
    s_waitcnt lgkmcnt(0)
    v_max3_f32 v17, v24, v25, v26
    v_max3_f32 v17, v17, v27, v28
    v_max3_f32 v17, v17, v29, v30
    v_max_f32 v17, v17, v31
    v_mul_f32 v17, v17, v18
    v_sqrt_f32 v17, v17
    s_nop 0
    v_sub_f32 v17, 0, v17
K2_MAIN:
    v_mov_b32 v32, v17
    v_mov_b32 v33, v17
    v_mov_b32 v34, v17
    v_mov_b32 v35, v17
    v_mov_b32 v36, v17
    v_mov_b32 v37, v17
    v_mov_b32 v38, v17
    v_mov_b32 v39, v17
    v_mov_b32 v40, v17
    v_mov_b32 v41, v17
    v_mov_b32 v42, v17
    v_mov_b32 v43, v17
    v_mov_b32 v44, v17
    v_mov_b32 v45, v17
    v_mov_b32 v46, v17
    v_mov_b32 v47, v17
    v_mov_b32 v80, 0
    v_mov_b32 v81, 0
    v_mov_b32 v82, 0
    v_mov_b32 v83, 0
    v_mov_b32 v84, 0
    v_mov_b32 v85, 0
    v_mov_b32 v86, 0
    v_mov_b32 v87, 0
    v_mov_b32 v88, 0
    v_mov_b32 v89, 0
    v_mov_b32 v90, 0
    v_mov_b32 v91, 0
    v_mov_b32 v92, 0
    v_mov_b32 v93, 0
    v_mov_b32 v94, 0
    v_mov_b32 v95, 0
    v_mov_b32 v14, v20
    v_mov_b32 v15, v21
    ds_read_b128 v[104:107], v14
    ds_read_b128 v[108:111], v14 offset:1024
    ds_read_b128 v[112:115], v15
    ds_read_b128 v[116:119], v15 offset:512
    s_waitcnt lgkmcnt(3)
    v_mfma_f32_32x32x16_bf16 v[48:63], v[104:107], v[8:11], v[32:47]
    s_nop 7
    s_mov_b32 s41, 0
K2_LOOP:
    s_cmp_lt_u32 s41, s42
    s_cbranch_scc1 K2_HOOK
K2_BODY:
    s_waitcnt lgkmcnt(2)
    v_mfma_f32_32x32x16_bf16 v[64:79], v[108:111], v[8:11], v[32:47]
    ds_read_b128 v[104:107], v14 offset:2048
    ds_read_b128 v[120:123], v15 offset:1024
    ds_read_b128 v[124:127], v15 offset:1536
    v_exp_f32 v48, v48
    v_exp_f32 v49, v49
    v_exp_f32 v50, v50
    v_exp_f32 v51, v51
    v_exp_f32 v52, v52
    v_exp_f32 v53, v53
    v_exp_f32 v54, v54
    v_exp_f32 v55, v55
    v_exp_f32 v56, v56
    v_cvt_pk_bf16_f32 v96, v48, v49
    v_cvt_pk_bf16_f32 v97, v50, v51
    v_cvt_pk_bf16_f32 v98, v52, v53
    v_cvt_pk_bf16_f32 v99, v54, v55
    v_exp_f32 v57, v57
    v_exp_f32 v58, v58
    s_waitcnt lgkmcnt(3)
    v_mfma_f32_32x32x16_bf16 v[80:95], v[112:115], v[96:99], v[80:95]
    v_exp_f32 v59, v59
    v_exp_f32 v60, v60
    v_exp_f32 v61, v61
    v_exp_f32 v62, v62
    v_exp_f32 v63, v63
    s_nop 0
    v_cvt_pk_bf16_f32 v100, v56, v57
    v_cvt_pk_bf16_f32 v101, v58, v59
    v_cvt_pk_bf16_f32 v102, v60, v61
    v_cvt_pk_bf16_f32 v103, v62, v63
    s_nop 1
    v_mfma_f32_32x32x16_bf16 v[80:95], v[116:119], v[100:103], v[80:95]
    s_waitcnt lgkmcnt(2)
    v_mfma_f32_32x32x16_bf16 v[48:63], v[104:107], v[8:11], v[32:47]
    ds_read_b128 v[108:111], v14 offset:3072
    ds_read_b128 v[112:115], v15 offset:2048
    ds_read_b128 v[116:119], v15 offset:2560
    v_exp_f32 v64, v64
    v_exp_f32 v65, v65
    v_exp_f32 v66, v66
    v_exp_f32 v67, v67
    v_exp_f32 v68, v68
    v_exp_f32 v69, v69
    v_exp_f32 v70, v70
    v_exp_f32 v71, v71
    v_exp_f32 v72, v72
    v_cvt_pk_bf16_f32 v96, v64, v65
    v_cvt_pk_bf16_f32 v97, v66, v67
    v_cvt_pk_bf16_f32 v98, v68, v69
    v_cvt_pk_bf16_f32 v99, v70, v71
    v_exp_f32 v73, v73
    v_exp_f32 v74, v74
    s_waitcnt lgkmcnt(3)
    v_mfma_f32_32x32x16_bf16 v[80:95], v[120:123], v[96:99], v[80:95]
    v_exp_f32 v75, v75
    v_exp_f32 v76, v76
    v_exp_f32 v77, v77
    v_exp_f32 v78, v78
    v_exp_f32 v79, v79
    s_nop 0
    v_cvt_pk_bf16_f32 v100, v72, v73
    v_cvt_pk_bf16_f32 v101, v74, v75
    v_cvt_pk_bf16_f32 v102, v76, v77
    v_cvt_pk_bf16_f32 v103, v78, v79
    s_nop 1
    v_mfma_f32_32x32x16_bf16 v[80:95], v[124:127], v[100:103], v[80:95]
    s_waitcnt lgkmcnt(2)
    v_mfma_f32_32x32x16_bf16 v[64:79], v[108:111], v[8:11], v[32:47]
    ds_read_b128 v[104:107], v14 offset:4096
    ds_read_b128 v[120:123], v15 offset:3072
    ds_read_b128 v[124:127], v15 offset:3584
    v_exp_f32 v48, v48
    v_exp_f32 v49, v49
    v_exp_f32 v50, v50
    v_exp_f32 v51, v51
    v_exp_f32 v52, v52
    v_exp_f32 v53, v53
    v_exp_f32 v54, v54
    v_exp_f32 v55, v55
    v_exp_f32 v56, v56
    v_cvt_pk_bf16_f32 v96, v48, v49
    v_cvt_pk_bf16_f32 v97, v50, v51
    v_cvt_pk_bf16_f32 v98, v52, v53
    v_cvt_pk_bf16_f32 v99, v54, v55
    v_exp_f32 v57, v57
    v_exp_f32 v58, v58
    s_waitcnt lgkmcnt(3)
    v_mfma_f32_32x32x16_bf16 v[80:95], v[112:115], v[96:99], v[80:95]
    v_exp_f32 v59, v59
    v_exp_f32 v60, v60
    v_exp_f32 v61, v61
    v_exp_f32 v62, v62
    v_exp_f32 v63, v63
    s_nop 0
    v_cvt_pk_bf16_f32 v100, v56, v57
    v_cvt_pk_bf16_f32 v101, v58, v59
    v_cvt_pk_bf16_f32 v102, v60, v61
    v_cvt_pk_bf16_f32 v103, v62, v63
    s_nop 1
    v_mfma_f32_32x32x16_bf16 v[80:95], v[116:119], v[100:103], v[80:95]
    s_waitcnt lgkmcnt(2)
    v_mfma_f32_32x32x16_bf16 v[48:63], v[104:107], v[8:11], v[32:47]
    ds_read_b128 v[108:111], v14 offset:5120
    ds_read_b128 v[112:115], v15 offset:4096
    ds_read_b128 v[116:119], v15 offset:4608
    v_exp_f32 v64, v64
    v_exp_f32 v65, v65
    v_exp_f32 v66, v66
    v_exp_f32 v67, v67
    v_exp_f32 v68, v68
    v_exp_f32 v69, v69
    v_exp_f32 v70, v70
    v_exp_f32 v71, v71
    v_exp_f32 v72, v72
    v_cvt_pk_bf16_f32 v96, v64, v65
    v_cvt_pk_bf16_f32 v97, v66, v67
    v_cvt_pk_bf16_f32 v98, v68, v69
    v_cvt_pk_bf16_f32 v99, v70, v71
    v_exp_f32 v73, v73
    v_exp_f32 v74, v74
    s_waitcnt lgkmcnt(3)
    v_mfma_f32_32x32x16_bf16 v[80:95], v[120:123], v[96:99], v[80:95]
    v_exp_f32 v75, v75
    v_exp_f32 v76, v76
    v_exp_f32 v77, v77
    v_exp_f32 v78, v78
    v_exp_f32 v79, v79
    s_nop 0
    v_cvt_pk_bf16_f32 v100, v72, v73
    v_cvt_pk_bf16_f32 v101, v74, v75
    v_cvt_pk_bf16_f32 v102, v76, v77
    v_cvt_pk_bf16_f32 v103, v78, v79
    v_add_u32 v14, 0x1000, v14
    v_add_u32 v15, v16, v15
    s_add_u32 s41, s41, 1
    s_cmp_lt_u32 s41, 16
    v_mfma_f32_32x32x16_bf16 v[80:95], v[124:127], v[100:103], v[80:95]
    s_cbranch_scc1 K2_LOOP
    s_waitcnt lgkmcnt(0)
    s_nop 15
    s_cmp_lg_u32 s40, 0
    s_cbranch_scc1 K2_EPI
    v_mov_b32 v18, 0x17800000
    v_cmp_nge_f32 vcc, v88, v18
    s_nop 3
    s_cbranch_vccz K2_EPI
    s_mov_b32 s40, 1
    s_mov_b32 s42, 0
    v_mov_b32 v14, v20
    v_mov_b32 v18, 0xff800000
    s_mov_b32 s41, 0
K2_MAXP:
    ds_read_b128 v[104:107], v14
    s_waitcnt lgkmcnt(0)
    v_mfma_f32_32x32x16_bf16 v[48:63], v[104:107], v[8:11], 0
    s_nop 15
    v_max3_f32 v18, v18, v48, v49
    v_max3_f32 v18, v18, v50, v51
    v_max3_f32 v18, v18, v52, v53
    v_max3_f32 v18, v18, v54, v55
    v_max3_f32 v18, v18, v56, v57
    v_max3_f32 v18, v18, v58, v59
    v_max3_f32 v18, v18, v60, v61
    v_max3_f32 v18, v18, v62, v63
    v_add_u32 v14, 0x400, v14
    s_add_u32 s41, s41, 1
    s_cmp_lt_u32 s41, 64
    s_cbranch_scc1 K2_MAXP
    v_mov_b32 v19, v18
    s_nop 1
    v_permlane32_swap_b32 v18, v19
    s_nop 1
    v_max_f32 v18, v18, v19
    v_sub_f32 v17, 0, v18
    s_branch K2_MAIN
K2_HOOK:
    s_cmp_eq_u32 s41, 1
    s_cbranch_scc0 K2_H3
    s_waitcnt vmcnt(0)
    s_barrier
    s_branch K2_BODY
K2_H3:
    s_cmp_eq_u32 s41, 3
    s_cbranch_scc1 K2_HB
    s_cmp_eq_u32 s41, 9
    s_cbranch_scc0 K2_BODY
K2_HB:
    s_barrier
    s_branch K2_BODY
K2_HELPER:
    s_sub_u32 s31, s31, s33
    s_sub_u32 s32, s32, s33
    s_mov_b32 s44, 16384
    s_mov_b32 s46, 0
    s_barrier
K2_HL:
    s_mov_b32 s33, 0
K2_HL2:
    s_add_u32 s34, s33, s44
    s_mov_b32 m0, s34
    s_add_u32 s35, s31, s34
    buffer_load_dwordx4 v5, s[24:27], s35 offen lds
    s_add_u32 s35, s32, s34
    s_add_u32 s34, s34, 65536
    s_mov_b32 m0, s34
    s_add_u32 s33, s33, 1024
    buffer_load_dwordx4 v5, s[24:27], s35 offen lds
    s_cmp_lt_u32 s33, 8192
    s_cbranch_scc1 K2_HL2
    s_add_u32 s44, s44, 8192
    s_add_u32 s46, s46, 1
    s_cmp_eq_u32 s46, 1
    s_cbranch_scc0 K2_HL3
    s_barrier
K2_HL3:
    s_cmp_lt_u32 s46, 6
    s_cbranch_scc1 K2_HL
    s_load_dwordx2 s[4:5], s[0:1], 16
    s_load_dwordx4 s[12:15], s[0:1], 40
    s_load_dwordx2 s[6:7], s[0:1], 56
    s_waitcnt vmcnt(48)
    s_barrier
    s_waitcnt vmcnt(0) lgkmcnt(0)
    s_barrier
    s_mov_b32 s48, s4
    s_mov_b32 s49, s5
    s_mov_b32 s50, 0x80000
    s_mov_b32 s51, 0x00020000
    s_mov_b32 s52, s12
    s_mov_b32 s53, s13
    s_mov_b32 s54, 0x1c0000
    s_mov_b32 s55, 0x00020000
    s_mov_b32 s56, s14
    s_mov_b32 s57, s15
    s_mov_b32 s58, 0x1c0000
    s_mov_b32 s59, 0x00020000
    s_mov_b32 s60, s6
    s_mov_b32 s61, s7
    s_mov_b32 s62, 0x1c0000
    s_mov_b32 s63, 0x00020000
    s_lshl_b32 s36, s2, 11
    buffer_load_dwordx4 v[32:35], v5, s[48:51], s36 offen offset:0
    buffer_load_dwordx4 v[36:39], v5, s[48:51], s36 offen offset:1024
    s_mul_i32 s36, s2, 7168
    s_add_u32 s37, s36, 4096
    buffer_load_dwordx4 v[40:43], v5, s[52:55], s36 offen offset:0
    buffer_load_dwordx4 v[44:47], v5, s[52:55], s36 offen offset:1024
    buffer_load_dwordx4 v[48:51], v5, s[52:55], s36 offen offset:2048
    buffer_load_dwordx4 v[52:55], v5, s[52:55], s36 offen offset:3072
    buffer_load_dwordx4 v[56:59], v5, s[52:55], s37 offen offset:0
    buffer_load_dwordx4 v[60:63], v5, s[52:55], s37 offen offset:1024
    buffer_load_dwordx4 v[64:67], v5, s[52:55], s37 offen offset:2048
    buffer_load_dwordx4 v[68:71], v5, s[56:59], s36 offen offset:0
    buffer_load_dwordx4 v[72:75], v5, s[56:59], s36 offen offset:1024
    buffer_load_dwordx4 v[76:79], v5, s[56:59], s36 offen offset:2048
    buffer_load_dwordx4 v[80:83], v5, s[56:59], s36 offen offset:3072
    buffer_load_dwordx4 v[84:87], v5, s[56:59], s37 offen offset:0
    buffer_load_dwordx4 v[88:91], v5, s[56:59], s37 offen offset:1024
    buffer_load_dwordx4 v[92:95], v5, s[56:59], s37 offen offset:2048
    buffer_load_dwordx4 v[96:99], v5, s[60:63], s36 offen offset:0
    buffer_load_dwordx4 v[100:103], v5, s[60:63], s36 offen offset:1024
    buffer_load_dwordx4 v[104:107], v5, s[60:63], s36 offen offset:2048
    buffer_load_dwordx4 v[108:111], v5, s[60:63], s36 offen offset:3072
    buffer_load_dwordx4 v[112:115], v5, s[60:63], s37 offen offset:0
    buffer_load_dwordx4 v[116:119], v5, s[60:63], s37 offen offset:1024
    buffer_load_dwordx4 v[120:123], v5, s[60:63], s37 offen offset:2048
    s_waitcnt vmcnt(0)
    s_branch K2_END
K2_EPI:
    v_rcp_f32 v18, v88
    s_nop 0
    v_mul_f32 v80, v80, v18
    v_mul_f32 v81, v81, v18
    v_mul_f32 v82, v82, v18
    v_mul_f32 v83, v83, v18
    v_mul_f32 v84, v84, v18
    v_mul_f32 v85, v85, v18
    v_mul_f32 v86, v86, v18
    v_mul_f32 v87, v87, v18
    v_cvt_pk_bf16_f32 v96, v80, v81
    v_cvt_pk_bf16_f32 v97, v82, v83
    v_cvt_pk_bf16_f32 v98, v84, v85
    v_cvt_pk_bf16_f32 v99, v86, v87
    s_lshl_b32 s45, s23, 5
    v_add_u32 v19, s45, v3
    v_lshlrev_b32 v19, 10, v19
    v_lshl_add_u32 v19, v4, 3, v19
    s_lshl_b32 s43, s3, 5
    s_add_u32 s43, s43, 0x600000
    buffer_store_dwordx2 v[96:97], v19, s[24:27], s43 offen
    buffer_store_dwordx2 v[98:99], v19, s[24:27], s43 offen offset:16
K2_END:
    s_endpgm
.globl k3_proj_kernel
.p2align 8
.type k3_proj_kernel,@function
k3_proj_kernel:
    s_cmp_ge_u32 s2, 256
    s_cbranch_scc1 K3_END
    s_load_dwordx2 s[4:5], s[0:1], 0
    s_load_dwordx2 s[6:7], s[0:1], 16
    s_load_dwordx2 s[8:9], s[0:1], 80
    s_load_dwordx2 s[44:45], s[0:1], 32
    v_lshrrev_b32 v1, 6, v0
    v_and_b32 v2, 63, v0
    s_nop 0
    v_readfirstlane_b32 s21, v1
    v_and_b32 v3, 15, v2
    v_lshrrev_b32 v4, 4, v2
    s_and_b32 s3, s2, 3
    s_lshr_b32 s20, s2, 2
    s_lshl_b32 s22, s20, 5
    s_lshl_b32 s23, s3, 8
    v_lshlrev_b32 v5, 13, v4
    v_lshl_add_u32 v5, v3, 4, v5
    v_add_u32 v5, s23, v5
    v_add_u32 v6, 0x1000, v5
    s_lshl_b32 s34, s21, 17
    v_add_u32 v7, s22, v3
    v_lshlrev_b32 v7, 10, v7
    v_lshl_add_u32 v7, v4, 4, v7
    s_lshl_b32 s35, s21, 8
    s_add_u32 s35, s35, 0x600000
    s_add_u32 s36, s35, 16384
    s_lshr_b32 s37, s21, 1
    s_lshl_b32 s37, s37, 4
    s_and_b32 s38, s21, 1
    s_lshl_b32 s38, s38, 1
    s_add_u32 s37, s37, s38
    s_add_u32 s37, s37, s22
    v_lshl_add_u32 v10, v4, 2, s37
    v_lshlrev_b32 v8, 10, v10
    v_lshl_add_u32 v8, v3, 4, v8
    v_add_u32 v8, s23, v8
    v_lshlrev_b32 v9, 4, v3
    v_add_u32 v9, s23, v9
    s_waitcnt lgkmcnt(0)
    s_mov_b32 s12, s4
    s_mov_b32 s13, s5
    s_mov_b32 s14, 0x200000
    s_mov_b32 s15, 0x00020000
    s_mov_b32 s16, s6
    s_mov_b32 s17, s7
    s_mov_b32 s18, 0x80000
    s_mov_b32 s19, 0x00020000
    s_mov_b32 s24, s8
    s_mov_b32 s25, s9
    s_mov_b32 s26, 0xe00000
    s_mov_b32 s27, 0x00020000
    s_mov_b32 s48, s44
    s_mov_b32 s49, s45
    s_mov_b32 s50, 0x400
    s_mov_b32 s51, 0x00020000
    s_add_u32 s39, s34, 0
    buffer_load_dwordx4 v[64:67], v5, s[16:19], s39 offen offset:0
    buffer_load_dwordx4 v[68:71], v5, s[16:19], s39 offen offset:1024
    buffer_load_dwordx4 v[72:75], v5, s[16:19], s39 offen offset:2048
    buffer_load_dwordx4 v[76:79], v5, s[16:19], s39 offen offset:3072
    buffer_load_dwordx4 v[80:83], v6, s[16:19], s39 offen offset:0
    buffer_load_dwordx4 v[84:87], v6, s[16:19], s39 offen offset:1024
    buffer_load_dwordx4 v[88:91], v6, s[16:19], s39 offen offset:2048
    buffer_load_dwordx4 v[92:95], v6, s[16:19], s39 offen offset:3072
    buffer_load_dwordx4 v[32:35], v7, s[24:27], s35 offen offset:0
    buffer_load_dwordx4 v[36:39], v7, s[24:27], s35 offen offset:64
    buffer_load_dwordx4 v[40:43], v7, s[24:27], s35 offen offset:128
    buffer_load_dwordx4 v[44:47], v7, s[24:27], s35 offen offset:192
    buffer_load_dwordx4 v[48:51], v7, s[24:27], s36 offen offset:0
    buffer_load_dwordx4 v[52:55], v7, s[24:27], s36 offen offset:64
    buffer_load_dwordx4 v[56:59], v7, s[24:27], s36 offen offset:128
    buffer_load_dwordx4 v[60:63], v7, s[24:27], s36 offen offset:192
    s_add_u32 s39, s34, 32768
    buffer_load_dwordx4 v[96:99], v5, s[16:19], s39 offen offset:0
    buffer_load_dwordx4 v[100:103], v5, s[16:19], s39 offen offset:1024
    buffer_load_dwordx4 v[104:107], v5, s[16:19], s39 offen offset:2048
    buffer_load_dwordx4 v[108:111], v5, s[16:19], s39 offen offset:3072
    buffer_load_dwordx4 v[112:115], v6, s[16:19], s39 offen offset:0
    buffer_load_dwordx4 v[116:119], v6, s[16:19], s39 offen offset:1024
    buffer_load_dwordx4 v[120:123], v6, s[16:19], s39 offen offset:2048
    buffer_load_dwordx4 v[124:127], v6, s[16:19], s39 offen offset:3072
    buffer_load_dwordx4 v[224:227], v8, s[12:15], 0 offen offset:0
    buffer_load_dwordx4 v[228:231], v8, s[12:15], 0 offen offset:1024
    buffer_load_dwordx4 v[232:235], v9, s[48:51], 0 offen
    v_mov_b32 v160, 0
    v_mov_b32 v161, 0
    v_mov_b32 v162, 0
    v_mov_b32 v163, 0
    v_mov_b32 v164, 0
    v_mov_b32 v165, 0
    v_mov_b32 v166, 0
    v_mov_b32 v167, 0
    v_mov_b32 v168, 0
    v_mov_b32 v169, 0
    v_mov_b32 v170, 0
    v_mov_b32 v171, 0
    v_mov_b32 v172, 0
    v_mov_b32 v173, 0
    v_mov_b32 v174, 0
    v_mov_b32 v175, 0
    v_mov_b32 v176, 0
    v_mov_b32 v177, 0
    v_mov_b32 v178, 0
    v_mov_b32 v179, 0
    v_mov_b32 v180, 0
    v_mov_b32 v181, 0
    v_mov_b32 v182, 0
    v_mov_b32 v183, 0
    v_mov_b32 v184, 0
    v_mov_b32 v185, 0
    v_mov_b32 v186, 0
    v_mov_b32 v187, 0
    v_mov_b32 v188, 0
    v_mov_b32 v189, 0
    v_mov_b32 v190, 0
    v_mov_b32 v191, 0
    v_mov_b32 v192, 0
    v_mov_b32 v193, 0
    v_mov_b32 v194, 0
    v_mov_b32 v195, 0
    v_mov_b32 v196, 0
    v_mov_b32 v197, 0
    v_mov_b32 v198, 0
    v_mov_b32 v199, 0
    v_mov_b32 v200, 0
    v_mov_b32 v201, 0
    v_mov_b32 v202, 0
    v_mov_b32 v203, 0
    v_mov_b32 v204, 0
    v_mov_b32 v205, 0
    v_mov_b32 v206, 0
    v_mov_b32 v207, 0
    v_mov_b32 v208, 0
    v_mov_b32 v209, 0
    v_mov_b32 v210, 0
    v_mov_b32 v211, 0
    v_mov_b32 v212, 0
    v_mov_b32 v213, 0
    v_mov_b32 v214, 0
    v_mov_b32 v215, 0
    v_mov_b32 v216, 0
    v_mov_b32 v217, 0
    v_mov_b32 v218, 0
    v_mov_b32 v219, 0
    v_mov_b32 v220, 0
    v_mov_b32 v221, 0
    v_mov_b32 v222, 0
    v_mov_b32 v223, 0
    s_mov_b32 s40, 0x05040100
    s_mov_b32 s41, 0x07060302
    s_waitcnt vmcnt(11)
    v_perm_b32 v128, v68, v64, s40
    v_perm_b32 v129, v76, v72, s40
    v_perm_b32 v130, v84, v80, s40
    v_perm_b32 v131, v92, v88, s40
    v_perm_b32 v132, v68, v64, s41
    v_perm_b32 v133, v76, v72, s41
    v_perm_b32 v134, v84, v80, s41
    v_perm_b32 v135, v92, v88, s41
    v_perm_b32 v136, v69, v65, s40
    v_perm_b32 v137, v77, v73, s40
    v_perm_b32 v138, v85, v81, s40
    v_perm_b32 v139, v93, v89, s40
    v_perm_b32 v140, v69, v65, s41
    v_perm_b32 v141, v77, v73, s41
    v_perm_b32 v142, v85, v81, s41
    v_perm_b32 v143, v93, v89, s41
    v_perm_b32 v144, v70, v66, s40
    v_perm_b32 v145, v78, v74, s40
    v_perm_b32 v146, v86, v82, s40
    v_perm_b32 v147, v94, v90, s40
    v_perm_b32 v148, v70, v66, s41
    v_perm_b32 v149, v78, v74, s41
    v_perm_b32 v150, v86, v82, s41
    v_perm_b32 v151, v94, v90, s41
    v_perm_b32 v152, v71, v67, s40
    v_perm_b32 v153, v79, v75, s40
    v_perm_b32 v154, v87, v83, s40
    v_perm_b32 v155, v95, v91, s40
    v_perm_b32 v156, v71, v67, s41
    v_perm_b32 v157, v79, v75, s41
    v_perm_b32 v158, v87, v83, s41
    v_perm_b32 v159, v95, v91, s41
    s_add_u32 s39, s34, 65536
    buffer_load_dwordx4 v[64:67], v5, s[16:19], s39 offen offset:0
    buffer_load_dwordx4 v[68:71], v5, s[16:19], s39 offen offset:1024
    buffer_load_dwordx4 v[72:75], v5, s[16:19], s39 offen offset:2048
    buffer_load_dwordx4 v[76:79], v5, s[16:19], s39 offen offset:3072
    buffer_load_dwordx4 v[80:83], v6, s[16:19], s39 offen offset:0
    buffer_load_dwordx4 v[84:87], v6, s[16:19], s39 offen offset:1024
    buffer_load_dwordx4 v[88:91], v6, s[16:19], s39 offen offset:2048
    buffer_load_dwordx4 v[92:95], v6, s[16:19], s39 offen offset:3072
    v_mfma_f32_16x16x32_bf16 v[160:163], v[32:35], v[128:131], v[160:163]
    v_mfma_f32_16x16x32_bf16 v[192:195], v[48:51], v[128:131], v[192:195]
    v_mfma_f32_16x16x32_bf16 v[164:167], v[32:35], v[132:135], v[164:167]
    v_mfma_f32_16x16x32_bf16 v[196:199], v[48:51], v[132:135], v[196:199]
    v_mfma_f32_16x16x32_bf16 v[168:171], v[32:35], v[136:139], v[168:171]
    v_mfma_f32_16x16x32_bf16 v[200:203], v[48:51], v[136:139], v[200:203]
    v_mfma_f32_16x16x32_bf16 v[172:175], v[32:35], v[140:143], v[172:175]
    v_mfma_f32_16x16x32_bf16 v[204:207], v[48:51], v[140:143], v[204:207]
    v_mfma_f32_16x16x32_bf16 v[176:179], v[32:35], v[144:147], v[176:179]
    v_mfma_f32_16x16x32_bf16 v[208:211], v[48:51], v[144:147], v[208:211]
    v_mfma_f32_16x16x32_bf16 v[180:183], v[32:35], v[148:151], v[180:183]
    v_mfma_f32_16x16x32_bf16 v[212:215], v[48:51], v[148:151], v[212:215]
    v_mfma_f32_16x16x32_bf16 v[184:187], v[32:35], v[152:155], v[184:187]
    v_mfma_f32_16x16x32_bf16 v[216:219], v[48:51], v[152:155], v[216:219]
    v_mfma_f32_16x16x32_bf16 v[188:191], v[32:35], v[156:159], v[188:191]
    v_mfma_f32_16x16x32_bf16 v[220:223], v[48:51], v[156:159], v[220:223]
    s_waitcnt vmcnt(11)
    v_perm_b32 v128, v100, v96, s40
    v_perm_b32 v129, v108, v104, s40
    v_perm_b32 v130, v116, v112, s40
    v_perm_b32 v131, v124, v120, s40
    v_perm_b32 v132, v100, v96, s41
    v_perm_b32 v133, v108, v104, s41
    v_perm_b32 v134, v116, v112, s41
    v_perm_b32 v135, v124, v120, s41
    v_perm_b32 v136, v101, v97, s40
    v_perm_b32 v137, v109, v105, s40
    v_perm_b32 v138, v117, v113, s40
    v_perm_b32 v139, v125, v121, s40
    v_perm_b32 v140, v101, v97, s41
    v_perm_b32 v141, v109, v105, s41
    v_perm_b32 v142, v117, v113, s41
    v_perm_b32 v143, v125, v121, s41
    v_perm_b32 v144, v102, v98, s40
    v_perm_b32 v145, v110, v106, s40
    v_perm_b32 v146, v118, v114, s40
    v_perm_b32 v147, v126, v122, s40
    v_perm_b32 v148, v102, v98, s41
    v_perm_b32 v149, v110, v106, s41
    v_perm_b32 v150, v118, v114, s41
    v_perm_b32 v151, v126, v122, s41
    v_perm_b32 v152, v103, v99, s40
    v_perm_b32 v153, v111, v107, s40
    v_perm_b32 v154, v119, v115, s40
    v_perm_b32 v155, v127, v123, s40
    v_perm_b32 v156, v103, v99, s41
    v_perm_b32 v157, v111, v107, s41
    v_perm_b32 v158, v119, v115, s41
    v_perm_b32 v159, v127, v123, s41
    s_add_u32 s39, s34, 98304
    buffer_load_dwordx4 v[96:99], v5, s[16:19], s39 offen offset:0
    buffer_load_dwordx4 v[100:103], v5, s[16:19], s39 offen offset:1024
    buffer_load_dwordx4 v[104:107], v5, s[16:19], s39 offen offset:2048
    buffer_load_dwordx4 v[108:111], v5, s[16:19], s39 offen offset:3072
    buffer_load_dwordx4 v[112:115], v6, s[16:19], s39 offen offset:0
    buffer_load_dwordx4 v[116:119], v6, s[16:19], s39 offen offset:1024
    buffer_load_dwordx4 v[120:123], v6, s[16:19], s39 offen offset:2048
    buffer_load_dwordx4 v[124:127], v6, s[16:19], s39 offen offset:3072
    v_mfma_f32_16x16x32_bf16 v[160:163], v[36:39], v[128:131], v[160:163]
    v_mfma_f32_16x16x32_bf16 v[192:195], v[52:55], v[128:131], v[192:195]
    v_mfma_f32_16x16x32_bf16 v[164:167], v[36:39], v[132:135], v[164:167]
    v_mfma_f32_16x16x32_bf16 v[196:199], v[52:55], v[132:135], v[196:199]
    v_mfma_f32_16x16x32_bf16 v[168:171], v[36:39], v[136:139], v[168:171]
    v_mfma_f32_16x16x32_bf16 v[200:203], v[52:55], v[136:139], v[200:203]
    v_mfma_f32_16x16x32_bf16 v[172:175], v[36:39], v[140:143], v[172:175]
    v_mfma_f32_16x16x32_bf16 v[204:207], v[52:55], v[140:143], v[204:207]
    v_mfma_f32_16x16x32_bf16 v[176:179], v[36:39], v[144:147], v[176:179]
    v_mfma_f32_16x16x32_bf16 v[208:211], v[52:55], v[144:147], v[208:211]
    v_mfma_f32_16x16x32_bf16 v[180:183], v[36:39], v[148:151], v[180:183]
    v_mfma_f32_16x16x32_bf16 v[212:215], v[52:55], v[148:151], v[212:215]
    v_mfma_f32_16x16x32_bf16 v[184:187], v[36:39], v[152:155], v[184:187]
    v_mfma_f32_16x16x32_bf16 v[216:219], v[52:55], v[152:155], v[216:219]
    v_mfma_f32_16x16x32_bf16 v[188:191], v[36:39], v[156:159], v[188:191]
    v_mfma_f32_16x16x32_bf16 v[220:223], v[52:55], v[156:159], v[220:223]
    s_waitcnt vmcnt(8)
    v_perm_b32 v128, v68, v64, s40
    v_perm_b32 v129, v76, v72, s40
    v_perm_b32 v130, v84, v80, s40
    v_perm_b32 v131, v92, v88, s40
    v_perm_b32 v132, v68, v64, s41
    v_perm_b32 v133, v76, v72, s41
    v_perm_b32 v134, v84, v80, s41
    v_perm_b32 v135, v92, v88, s41
    v_perm_b32 v136, v69, v65, s40
    v_perm_b32 v137, v77, v73, s40
    v_perm_b32 v138, v85, v81, s40
    v_perm_b32 v139, v93, v89, s40
    v_perm_b32 v140, v69, v65, s41
    v_perm_b32 v141, v77, v73, s41
    v_perm_b32 v142, v85, v81, s41
    v_perm_b32 v143, v93, v89, s41
    v_perm_b32 v144, v70, v66, s40
    v_perm_b32 v145, v78, v74, s40
    v_perm_b32 v146, v86, v82, s40
    v_perm_b32 v147, v94, v90, s40
    v_perm_b32 v148, v70, v66, s41
    v_perm_b32 v149, v78, v74, s41
    v_perm_b32 v150, v86, v82, s41
    v_perm_b32 v151, v94, v90, s41
    v_perm_b32 v152, v71, v67, s40
    v_perm_b32 v153, v79, v75, s40
    v_perm_b32 v154, v87, v83, s40
    v_perm_b32 v155, v95, v91, s40
    v_perm_b32 v156, v71, v67, s41
    v_perm_b32 v157, v79, v75, s41
    v_perm_b32 v158, v87, v83, s41
    v_perm_b32 v159, v95, v91, s41
    s_nop 0
    v_mfma_f32_16x16x32_bf16 v[160:163], v[40:43], v[128:131], v[160:163]
    v_mfma_f32_16x16x32_bf16 v[192:195], v[56:59], v[128:131], v[192:195]
    v_mfma_f32_16x16x32_bf16 v[164:167], v[40:43], v[132:135], v[164:167]
    v_mfma_f32_16x16x32_bf16 v[196:199], v[56:59], v[132:135], v[196:199]
    v_mfma_f32_16x16x32_bf16 v[168:171], v[40:43], v[136:139], v[168:171]
    v_mfma_f32_16x16x32_bf16 v[200:203], v[56:59], v[136:139], v[200:203]
    v_mfma_f32_16x16x32_bf16 v[172:175], v[40:43], v[140:143], v[172:175]
    v_mfma_f32_16x16x32_bf16 v[204:207], v[56:59], v[140:143], v[204:207]
    v_mfma_f32_16x16x32_bf16 v[176:179], v[40:43], v[144:147], v[176:179]
    v_mfma_f32_16x16x32_bf16 v[208:211], v[56:59], v[144:147], v[208:211]
    v_mfma_f32_16x16x32_bf16 v[180:183], v[40:43], v[148:151], v[180:183]
    v_mfma_f32_16x16x32_bf16 v[212:215], v[56:59], v[148:151], v[212:215]
    v_mfma_f32_16x16x32_bf16 v[184:187], v[40:43], v[152:155], v[184:187]
    v_mfma_f32_16x16x32_bf16 v[216:219], v[56:59], v[152:155], v[216:219]
    v_mfma_f32_16x16x32_bf16 v[188:191], v[40:43], v[156:159], v[188:191]
    v_mfma_f32_16x16x32_bf16 v[220:223], v[56:59], v[156:159], v[220:223]
    s_waitcnt vmcnt(0)
    v_perm_b32 v128, v100, v96, s40
    v_perm_b32 v129, v108, v104, s40
    v_perm_b32 v130, v116, v112, s40
    v_perm_b32 v131, v124, v120, s40
    v_perm_b32 v132, v100, v96, s41
    v_perm_b32 v133, v108, v104, s41
    v_perm_b32 v134, v116, v112, s41
    v_perm_b32 v135, v124, v120, s41
    v_perm_b32 v136, v101, v97, s40
    v_perm_b32 v137, v109, v105, s40
    v_perm_b32 v138, v117, v113, s40
    v_perm_b32 v139, v125, v121, s40
    v_perm_b32 v140, v101, v97, s41
    v_perm_b32 v141, v109, v105, s41
    v_perm_b32 v142, v117, v113, s41
    v_perm_b32 v143, v125, v121, s41
    v_perm_b32 v144, v102, v98, s40
    v_perm_b32 v145, v110, v106, s40
    v_perm_b32 v146, v118, v114, s40
    v_perm_b32 v147, v126, v122, s40
    v_perm_b32 v148, v102, v98, s41
    v_perm_b32 v149, v110, v106, s41
    v_perm_b32 v150, v118, v114, s41
    v_perm_b32 v151, v126, v122, s41
    v_perm_b32 v152, v103, v99, s40
    v_perm_b32 v153, v111, v107, s40
    v_perm_b32 v154, v119, v115, s40
    v_perm_b32 v155, v127, v123, s40
    v_perm_b32 v156, v103, v99, s41
    v_perm_b32 v157, v111, v107, s41
    v_perm_b32 v158, v119, v115, s41
    v_perm_b32 v159, v127, v123, s41
    s_nop 0
    v_mfma_f32_16x16x32_bf16 v[160:163], v[44:47], v[128:131], v[160:163]
    v_mfma_f32_16x16x32_bf16 v[192:195], v[60:63], v[128:131], v[192:195]
    v_mfma_f32_16x16x32_bf16 v[164:167], v[44:47], v[132:135], v[164:167]
    v_mfma_f32_16x16x32_bf16 v[196:199], v[60:63], v[132:135], v[196:199]
    v_mfma_f32_16x16x32_bf16 v[168:171], v[44:47], v[136:139], v[168:171]
    v_mfma_f32_16x16x32_bf16 v[200:203], v[60:63], v[136:139], v[200:203]
    v_mfma_f32_16x16x32_bf16 v[172:175], v[44:47], v[140:143], v[172:175]
    v_mfma_f32_16x16x32_bf16 v[204:207], v[60:63], v[140:143], v[204:207]
    v_mfma_f32_16x16x32_bf16 v[176:179], v[44:47], v[144:147], v[176:179]
    v_mfma_f32_16x16x32_bf16 v[208:211], v[60:63], v[144:147], v[208:211]
    v_mfma_f32_16x16x32_bf16 v[180:183], v[44:47], v[148:151], v[180:183]
    v_mfma_f32_16x16x32_bf16 v[212:215], v[60:63], v[148:151], v[212:215]
    v_mfma_f32_16x16x32_bf16 v[184:187], v[44:47], v[152:155], v[184:187]
    v_mfma_f32_16x16x32_bf16 v[216:219], v[60:63], v[152:155], v[216:219]
    v_mfma_f32_16x16x32_bf16 v[188:191], v[44:47], v[156:159], v[188:191]
    v_mfma_f32_16x16x32_bf16 v[220:223], v[60:63], v[156:159], v[220:223]
    s_nop 9
    v_lshlrev_b32 v11, 3, v2
    s_lshl_b32 s39, s21, 12
    v_add_u32 v12, s39, v11
    ds_write_b64 v12, v[160:161] offset:0
    ds_write_b64 v12, v[164:165] offset:512
    ds_write_b64 v12, v[168:169] offset:1024
    ds_write_b64 v12, v[172:173] offset:1536
    ds_write_b64 v12, v[176:177] offset:2048
    ds_write_b64 v12, v[180:181] offset:2560
    ds_write_b64 v12, v[184:185] offset:3072
    ds_write_b64 v12, v[188:189] offset:3584
    ds_write_b64 v12, v[162:163] offset:16384
    ds_write_b64 v12, v[166:167] offset:16896
    ds_write_b64 v12, v[170:171] offset:17408
    ds_write_b64 v12, v[174:175] offset:17920
    ds_write_b64 v12, v[178:179] offset:18432
    ds_write_b64 v12, v[182:183] offset:18944
    ds_write_b64 v12, v[186:187] offset:19456
    ds_write_b64 v12, v[190:191] offset:19968
    ds_write_b64 v12, v[192:193] offset:32768
    ds_write_b64 v12, v[196:197] offset:33280
    ds_write_b64 v12, v[200:201] offset:33792
    ds_write_b64 v12, v[204:205] offset:34304
    ds_write_b64 v12, v[208:209] offset:34816
    ds_write_b64 v12, v[212:213] offset:35328
    ds_write_b64 v12, v[216:217] offset:35840
    ds_write_b64 v12, v[220:221] offset:36352
    ds_write_b64 v12, v[194:195] offset:49152
    ds_write_b64 v12, v[198:199] offset:49664
    ds_write_b64 v12, v[202:203] offset:50176
    ds_write_b64 v12, v[206:207] offset:50688
    ds_write_b64 v12, v[210:211] offset:51200
    ds_write_b64 v12, v[214:215] offset:51712
    ds_write_b64 v12, v[218:219] offset:52224
    ds_write_b64 v12, v[222:223] offset:52736
    s_waitcnt lgkmcnt(0)
    s_barrier
    s_lshl_b32 s39, s21, 14
    v_add_u32 v12, s39, v11
    ds_read_b64 v[64:65], v12 offset:0
    ds_read_b64 v[66:67], v12 offset:512
    ds_read_b64 v[68:69], v12 offset:1024
    ds_read_b64 v[70:71], v12 offset:1536
    ds_read_b64 v[72:73], v12 offset:2048
    ds_read_b64 v[74:75], v12 offset:2560
    ds_read_b64 v[76:77], v12 offset:3072
    ds_read_b64 v[78:79], v12 offset:3584
    ds_read_b64 v[80:81], v12 offset:4096
    ds_read_b64 v[82:83], v12 offset:4608
    ds_read_b64 v[84:85], v12 offset:5120
    ds_read_b64 v[86:87], v12 offset:5632
    ds_read_b64 v[88:89], v12 offset:6144
    ds_read_b64 v[90:91], v12 offset:6656
    ds_read_b64 v[92:93], v12 offset:7168
    ds_read_b64 v[94:95], v12 offset:7680
    ds_read_b64 v[96:97], v12 offset:8192
    ds_read_b64 v[98:99], v12 offset:8704
    ds_read_b64 v[100:101], v12 offset:9216
    ds_read_b64 v[102:103], v12 offset:9728
    ds_read_b64 v[104:105], v12 offset:10240
    ds_read_b64 v[106:107], v12 offset:10752
    ds_read_b64 v[108:109], v12 offset:11264
    ds_read_b64 v[110:111], v12 offset:11776
    ds_read_b64 v[112:113], v12 offset:12288
    ds_read_b64 v[114:115], v12 offset:12800
    ds_read_b64 v[116:117], v12 offset:13312
    ds_read_b64 v[118:119], v12 offset:13824
    ds_read_b64 v[120:121], v12 offset:14336
    ds_read_b64 v[122:123], v12 offset:14848
    ds_read_b64 v[124:125], v12 offset:15360
    ds_read_b64 v[126:127], v12 offset:15872
    s_waitcnt lgkmcnt(0)
    v_add_f32 v64, v64, v80
    v_add_f32 v96, v96, v112
    v_add_f32 v64, v64, v96
    v_add_f32 v65, v65, v81
    v_add_f32 v97, v97, v113
    v_add_f32 v65, v65, v97
    v_add_f32 v66, v66, v82
    v_add_f32 v98, v98, v114
    v_add_f32 v66, v66, v98
    v_add_f32 v67, v67, v83
    v_add_f32 v99, v99, v115
    v_add_f32 v67, v67, v99
    v_add_f32 v68, v68, v84
    v_add_f32 v100, v100, v116
    v_add_f32 v68, v68, v100
    v_add_f32 v69, v69, v85
    v_add_f32 v101, v101, v117
    v_add_f32 v69, v69, v101
    v_add_f32 v70, v70, v86
    v_add_f32 v102, v102, v118
    v_add_f32 v70, v70, v102
    v_add_f32 v71, v71, v87
    v_add_f32 v103, v103, v119
    v_add_f32 v71, v71, v103
    v_add_f32 v72, v72, v88
    v_add_f32 v104, v104, v120
    v_add_f32 v72, v72, v104
    v_add_f32 v73, v73, v89
    v_add_f32 v105, v105, v121
    v_add_f32 v73, v73, v105
    v_add_f32 v74, v74, v90
    v_add_f32 v106, v106, v122
    v_add_f32 v74, v74, v106
    v_add_f32 v75, v75, v91
    v_add_f32 v107, v107, v123
    v_add_f32 v75, v75, v107
    v_add_f32 v76, v76, v92
    v_add_f32 v108, v108, v124
    v_add_f32 v76, v76, v108
    v_add_f32 v77, v77, v93
    v_add_f32 v109, v109, v125
    v_add_f32 v77, v77, v109
    v_add_f32 v78, v78, v94
    v_add_f32 v110, v110, v126
    v_add_f32 v78, v78, v110
    v_add_f32 v79, v79, v95
    v_add_f32 v111, v111, v127
    v_add_f32 v79, v79, v111
    v_lshlrev_b32 v160, 16, v232
    v_and_b32 v161, 0xffff0000, v232
    v_lshlrev_b32 v162, 16, v233
    v_and_b32 v163, 0xffff0000, v233
    v_lshlrev_b32 v164, 16, v234
    v_and_b32 v165, 0xffff0000, v234
    v_lshlrev_b32 v166, 16, v235
    v_and_b32 v167, 0xffff0000, v235
    v_mov_b32 v16, 0
    v_mov_b32 v17, 0
    v_mov_b32 v18, 0
    v_cvt_pk_bf16_f32 v128, v64, v66
    v_lshlrev_b32 v129, 16, v128
    v_and_b32 v130, 0xffff0000, v128
    v_lshlrev_b32 v131, 16, v224
    v_and_b32 v132, 0xffff0000, v224
    v_add_f32 v129, v129, v131
    v_add_f32 v130, v130, v132
    v_cvt_pk_bf16_f32 v144, v129, v130
    v_lshlrev_b32 v129, 16, v144
    v_and_b32 v130, 0xffff0000, v144
    v_add_f32 v16, v16, v129
    v_fmac_f32 v17, v129, v129
    v_fmac_f32 v18, v129, v160
    v_add_f32 v16, v16, v130
    v_fmac_f32 v17, v130, v130
    v_fmac_f32 v18, v130, v161
    v_cvt_pk_bf16_f32 v128, v68, v70
    v_lshlrev_b32 v129, 16, v128
    v_and_b32 v130, 0xffff0000, v128
    v_lshlrev_b32 v131, 16, v225
    v_and_b32 v132, 0xffff0000, v225
    v_add_f32 v129, v129, v131
    v_add_f32 v130, v130, v132
    v_cvt_pk_bf16_f32 v145, v129, v130
    v_lshlrev_b32 v129, 16, v145
    v_and_b32 v130, 0xffff0000, v145
    v_add_f32 v16, v16, v129
    v_fmac_f32 v17, v129, v129
    v_fmac_f32 v18, v129, v162
    v_add_f32 v16, v16, v130
    v_fmac_f32 v17, v130, v130
    v_fmac_f32 v18, v130, v163
    v_cvt_pk_bf16_f32 v128, v72, v74
    v_lshlrev_b32 v129, 16, v128
    v_and_b32 v130, 0xffff0000, v128
    v_lshlrev_b32 v131, 16, v226
    v_and_b32 v132, 0xffff0000, v226
    v_add_f32 v129, v129, v131
    v_add_f32 v130, v130, v132
    v_cvt_pk_bf16_f32 v146, v129, v130
    v_lshlrev_b32 v129, 16, v146
    v_and_b32 v130, 0xffff0000, v146
    v_add_f32 v16, v16, v129
    v_fmac_f32 v17, v129, v129
    v_fmac_f32 v18, v129, v164
    v_add_f32 v16, v16, v130
    v_fmac_f32 v17, v130, v130
    v_fmac_f32 v18, v130, v165
    v_cvt_pk_bf16_f32 v128, v76, v78
    v_lshlrev_b32 v129, 16, v128
    v_and_b32 v130, 0xffff0000, v128
    v_lshlrev_b32 v131, 16, v227
    v_and_b32 v132, 0xffff0000, v227
    v_add_f32 v129, v129, v131
    v_add_f32 v130, v130, v132
    v_cvt_pk_bf16_f32 v147, v129, v130
    v_lshlrev_b32 v129, 16, v147
    v_and_b32 v130, 0xffff0000, v147
    v_add_f32 v16, v16, v129
    v_fmac_f32 v17, v129, v129
    v_fmac_f32 v18, v129, v166
    v_add_f32 v16, v16, v130
    v_fmac_f32 v17, v130, v130
    v_fmac_f32 v18, v130, v167
    v_mov_b32 v19, 0
    v_mov_b32 v20, 0
    v_mov_b32 v21, 0
    v_cvt_pk_bf16_f32 v128, v65, v67
    v_lshlrev_b32 v129, 16, v128
    v_and_b32 v130, 0xffff0000, v128
    v_lshlrev_b32 v131, 16, v228
    v_and_b32 v132, 0xffff0000, v228
    v_add_f32 v129, v129, v131
    v_add_f32 v130, v130, v132
    v_cvt_pk_bf16_f32 v148, v129, v130
    v_lshlrev_b32 v129, 16, v148
    v_and_b32 v130, 0xffff0000, v148
    v_add_f32 v19, v19, v129
    v_fmac_f32 v20, v129, v129
    v_fmac_f32 v21, v129, v160
    v_add_f32 v19, v19, v130
    v_fmac_f32 v20, v130, v130
    v_fmac_f32 v21, v130, v161
    v_cvt_pk_bf16_f32 v128, v69, v71
    v_lshlrev_b32 v129, 16, v128
    v_and_b32 v130, 0xffff0000, v128
    v_lshlrev_b32 v131, 16, v229
    v_and_b32 v132, 0xffff0000, v229
    v_add_f32 v129, v129, v131
    v_add_f32 v130, v130, v132
    v_cvt_pk_bf16_f32 v149, v129, v130
    v_lshlrev_b32 v129, 16, v149
    v_and_b32 v130, 0xffff0000, v149
    v_add_f32 v19, v19, v129
    v_fmac_f32 v20, v129, v129
    v_fmac_f32 v21, v129, v162
    v_add_f32 v19, v19, v130
    v_fmac_f32 v20, v130, v130
    v_fmac_f32 v21, v130, v163
    v_cvt_pk_bf16_f32 v128, v73, v75
    v_lshlrev_b32 v129, 16, v128
    v_and_b32 v130, 0xffff0000, v128
    v_lshlrev_b32 v131, 16, v230
    v_and_b32 v132, 0xffff0000, v230
    v_add_f32 v129, v129, v131
    v_add_f32 v130, v130, v132
    v_cvt_pk_bf16_f32 v150, v129, v130
    v_lshlrev_b32 v129, 16, v150
    v_and_b32 v130, 0xffff0000, v150
    v_add_f32 v19, v19, v129
    v_fmac_f32 v20, v129, v129
    v_fmac_f32 v21, v129, v164
    v_add_f32 v19, v19, v130
    v_fmac_f32 v20, v130, v130
    v_fmac_f32 v21, v130, v165
    v_cvt_pk_bf16_f32 v128, v77, v79
    v_lshlrev_b32 v129, 16, v128
    v_and_b32 v130, 0xffff0000, v128
    v_lshlrev_b32 v131, 16, v231
    v_and_b32 v132, 0xffff0000, v231
    v_add_f32 v129, v129, v131
    v_add_f32 v130, v130, v132
    v_cvt_pk_bf16_f32 v151, v129, v130
    v_lshlrev_b32 v129, 16, v151
    v_and_b32 v130, 0xffff0000, v151
    v_add_f32 v19, v19, v129
    v_fmac_f32 v20, v129, v129
    v_fmac_f32 v21, v129, v166
    v_add_f32 v19, v19, v130
    v_fmac_f32 v20, v130, v130
    v_fmac_f32 v21, v130, v167
    s_mov_b32 s38, 0x800000
    buffer_store_dwordx4 v[144:147], v8, s[24:27], s38 offen offset:0
    buffer_store_dwordx4 v[148:151], v8, s[24:27], s38 offen offset:1024
    s_nop 1
    v_add_f32_dpp v16, v16, v16 row_ror:8 row_mask:0xf bank_mask:0xf
    v_add_f32_dpp v17, v17, v17 row_ror:8 row_mask:0xf bank_mask:0xf
    v_add_f32_dpp v18, v18, v18 row_ror:8 row_mask:0xf bank_mask:0xf
    v_add_f32_dpp v19, v19, v19 row_ror:8 row_mask:0xf bank_mask:0xf
    v_add_f32_dpp v20, v20, v20 row_ror:8 row_mask:0xf bank_mask:0xf
    v_add_f32_dpp v21, v21, v21 row_ror:8 row_mask:0xf bank_mask:0xf
    s_nop 1
    v_add_f32_dpp v16, v16, v16 row_ror:4 row_mask:0xf bank_mask:0xf
    v_add_f32_dpp v17, v17, v17 row_ror:4 row_mask:0xf bank_mask:0xf
    v_add_f32_dpp v18, v18, v18 row_ror:4 row_mask:0xf bank_mask:0xf
    v_add_f32_dpp v19, v19, v19 row_ror:4 row_mask:0xf bank_mask:0xf
    v_add_f32_dpp v20, v20, v20 row_ror:4 row_mask:0xf bank_mask:0xf
    v_add_f32_dpp v21, v21, v21 row_ror:4 row_mask:0xf bank_mask:0xf
    s_nop 1
    v_add_f32_dpp v16, v16, v16 row_ror:2 row_mask:0xf bank_mask:0xf
    v_add_f32_dpp v17, v17, v17 row_ror:2 row_mask:0xf bank_mask:0xf
    v_add_f32_dpp v18, v18, v18 row_ror:2 row_mask:0xf bank_mask:0xf
    v_add_f32_dpp v19, v19, v19 row_ror:2 row_mask:0xf bank_mask:0xf
    v_add_f32_dpp v20, v20, v20 row_ror:2 row_mask:0xf bank_mask:0xf
    v_add_f32_dpp v21, v21, v21 row_ror:2 row_mask:0xf bank_mask:0xf
    s_nop 1
    v_add_f32_dpp v16, v16, v16 row_ror:1 row_mask:0xf bank_mask:0xf
    v_add_f32_dpp v17, v17, v17 row_ror:1 row_mask:0xf bank_mask:0xf
    v_add_f32_dpp v18, v18, v18 row_ror:1 row_mask:0xf bank_mask:0xf
    v_add_f32_dpp v19, v19, v19 row_ror:1 row_mask:0xf bank_mask:0xf
    v_add_f32_dpp v20, v20, v20 row_ror:1 row_mask:0xf bank_mask:0xf
    v_add_f32_dpp v21, v21, v21 row_ror:1 row_mask:0xf bank_mask:0xf
    v_and_b32 v13, 7, v10
    v_mul_u32_u24 v13, 0x3000, v13
    v_lshrrev_b32 v14, 3, v10
    v_lshl_add_u32 v13, v14, 4, v13
    s_lshl_b32 s39, s3, 2
    s_add_u32 s39, s39, 0xc80000
    s_add_u32 s38, s39, 0
    buffer_store_dword v16, v13, s[24:27], s38 offen
    s_add_u32 s38, s39, 4096
    buffer_store_dword v17, v13, s[24:27], s38 offen
    s_add_u32 s38, s39, 8192
    buffer_store_dword v18, v13, s[24:27], s38 offen
    s_add_u32 s38, s39, 12288
    buffer_store_dword v19, v13, s[24:27], s38 offen
    s_add_u32 s38, s39, 16384
    buffer_store_dword v20, v13, s[24:27], s38 offen
    s_add_u32 s38, s39, 20480
    buffer_store_dword v21, v13, s[24:27], s38 offen
    s_cmp_lg_u32 s20, 0
    s_cbranch_scc1 K3_END
    v_add_f32 v30, v160, v161
    v_add_f32 v30, v30, v162
    v_add_f32 v30, v30, v163
    v_add_f32 v30, v30, v164
    v_add_f32 v30, v30, v165
    v_add_f32 v30, v30, v166
    v_add_f32 v30, v30, v167
    s_nop 1
    v_add_f32_dpp v30, v30, v30 row_ror:8 row_mask:0xf bank_mask:0xf
    s_nop 1
    v_add_f32_dpp v30, v30, v30 row_ror:4 row_mask:0xf bank_mask:0xf
    s_nop 1
    v_add_f32_dpp v30, v30, v30 row_ror:2 row_mask:0xf bank_mask:0xf
    s_nop 1
    v_add_f32_dpp v30, v30, v30 row_ror:1 row_mask:0xf bank_mask:0xf
    v_mov_b32 v31, 0
    s_lshl_b32 s39, s3, 2
    s_add_u32 s39, s39, 0xc98000
    buffer_store_dword v30, v31, s[24:27], s39 offen
K3_END:
    s_endpgm
.globl k4a_ffn1_kernel
.p2align 8
.type k4a_ffn1_kernel,@function
k4a_ffn1_kernel:
    s_cmp_ge_u32 s2, 184
    s_cbranch_scc1 K4A_END
    s_load_dwordx2 s[4:5], s[0:1], 40
    s_load_dwordx2 s[6:7], s[0:1], 48
    s_load_dwordx2 s[8:9], s[0:1], 80
    s_load_dwordx2 s[10:11], s[0:1], 56
    s_load_dwordx2 s[44:45], s[0:1], 32
    s_load_dwordx2 s[46:47], s[0:1], 64
    v_lshrrev_b32 v1, 6, v0
    v_and_b32 v2, 63, v0
    s_nop 0
    v_readfirstlane_b32 s21, v1
    v_lshlrev_b32 v5, 4, v2
    s_waitcnt lgkmcnt(0)
    s_mov_b32 s24, s8
    s_mov_b32 s25, s9
    s_mov_b32 s26, 0xe00000
    s_mov_b32 s27, 0x00020000
    s_cmp_lt_u32 s2, 56
    s_cbranch_scc1 K4A_FFN
    s_mov_b32 s28, s46
    s_mov_b32 s29, s47
    s_mov_b32 s30, 0x200000
    s_mov_b32 s31, 0x00020000
    s_sub_u32 s22, s2, 56
    s_lshl_b32 s22, s22, 4
    s_add_u32 s22, s22, s21
    s_lshl_b32 s23, s22, 10
    s_add_u32 s52, s23, 0x800000
    buffer_load_dwordx4 v[32:35], v5, s[24:27], s52 offen
    s_and_b32 s53, s22, 7
    s_mul_i32 s53, s53, 0x3000
    s_lshr_b32 s34, s22, 3
    s_lshl_b32 s34, s34, 4
    s_add_u32 s53, s53, s34
    s_add_u32 s53, s53, 0xc80000
    s_add_u32 s32, s8, s53
    s_addc_u32 s33, s9, 0
    s_load_dwordx4 s[56:59], s[32:33], 0
    s_load_dwordx4 s[60:63], s[32:33], 4096
    s_waitcnt lgkmcnt(0)
    v_mov_b32 v8, s56
    v_add_f32 v8, s57, v8
    v_add_f32 v8, s58, v8
    v_add_f32 v8, s59, v8
    v_mov_b32 v9, s60
    v_add_f32 v9, s61, v9
    v_add_f32 v9, s62, v9
    v_add_f32 v9, s63, v9
    v_mul_f32 v8, 0x3b000000, v8
    v_mul_f32 v9, 0x3b000000, v9
    v_fma_f32 v9, -v8, v8, v9
    v_max_f32 v9, 0, v9
    v_cvt_pk_bf16_f32 v8, v8, v8
    v_lshlrev_b32 v8, 16, v8
    v_cvt_pk_bf16_f32 v9, v9, v9
    v_lshlrev_b32 v9, 16, v9
    v_add_f32 v9, 0x3727c5ac, v9
    v_cvt_pk_bf16_f32 v9, v9, v9
    v_lshlrev_b32 v9, 16, v9
    v_sqrt_f32 v9, v9
    s_nop 0
    v_cvt_pk_bf16_f32 v9, v9, v9
    v_lshlrev_b32 v9, 16, v9
    v_rcp_f32 v10, v9
    s_nop 0
    s_waitcnt vmcnt(0)
    v_lshlrev_b32 v55, 16, v32
    v_and_b32 v56, 0xffff0000, v32
    v_sub_f32 v48, v55, v8
    v_sub_f32 v49, v56, v8
    v_cvt_pk_bf16_f32 v50, v48, v49
    v_lshlrev_b32 v48, 16, v50
    v_and_b32 v49, 0xffff0000, v50
    v_mul_f32 v51, v48, v10
    v_mul_f32 v52, v49, v10
    v_fma_f32 v53, -v51, v9, v48
    v_fma_f32 v54, -v52, v9, v49
    v_fmac_f32 v51, v53, v10
    v_fmac_f32 v52, v54, v10
    v_cvt_pk_bf16_f32 v58, v51, v52
    v_lshlrev_b32 v48, 16, v58
    v_and_b32 v49, 0xffff0000, v58
    v_add_f32 v48, v48, v55
    v_add_f32 v49, v49, v56
    v_cvt_pk_bf16_f32 v36, v48, v49
    v_lshlrev_b32 v55, 16, v33
    v_and_b32 v56, 0xffff0000, v33
    v_sub_f32 v48, v55, v8
    v_sub_f32 v49, v56, v8
    v_cvt_pk_bf16_f32 v50, v48, v49
    v_lshlrev_b32 v48, 16, v50
    v_and_b32 v49, 0xffff0000, v50
    v_mul_f32 v51, v48, v10
    v_mul_f32 v52, v49, v10
    v_fma_f32 v53, -v51, v9, v48
    v_fma_f32 v54, -v52, v9, v49
    v_fmac_f32 v51, v53, v10
    v_fmac_f32 v52, v54, v10
    v_cvt_pk_bf16_f32 v58, v51, v52
    v_lshlrev_b32 v48, 16, v58
    v_and_b32 v49, 0xffff0000, v58
    v_add_f32 v48, v48, v55
    v_add_f32 v49, v49, v56
    v_cvt_pk_bf16_f32 v37, v48, v49
    v_lshlrev_b32 v55, 16, v34
    v_and_b32 v56, 0xffff0000, v34
    v_sub_f32 v48, v55, v8
    v_sub_f32 v49, v56, v8
    v_cvt_pk_bf16_f32 v50, v48, v49
    v_lshlrev_b32 v48, 16, v50
    v_and_b32 v49, 0xffff0000, v50
    v_mul_f32 v51, v48, v10
    v_mul_f32 v52, v49, v10
    v_fma_f32 v53, -v51, v9, v48
    v_fma_f32 v54, -v52, v9, v49
    v_fmac_f32 v51, v53, v10
    v_fmac_f32 v52, v54, v10
    v_cvt_pk_bf16_f32 v58, v51, v52
    v_lshlrev_b32 v48, 16, v58
    v_and_b32 v49, 0xffff0000, v58
    v_add_f32 v48, v48, v55
    v_add_f32 v49, v49, v56
    v_cvt_pk_bf16_f32 v38, v48, v49
    v_lshlrev_b32 v55, 16, v35
    v_and_b32 v56, 0xffff0000, v35
    v_sub_f32 v48, v55, v8
    v_sub_f32 v49, v56, v8
    v_cvt_pk_bf16_f32 v50, v48, v49
    v_lshlrev_b32 v48, 16, v50
    v_and_b32 v49, 0xffff0000, v50
    v_mul_f32 v51, v48, v10
    v_mul_f32 v52, v49, v10
    v_fma_f32 v53, -v51, v9, v48
    v_fma_f32 v54, -v52, v9, v49
    v_fmac_f32 v51, v53, v10
    v_fmac_f32 v52, v54, v10
    v_cvt_pk_bf16_f32 v58, v51, v52
    v_lshlrev_b32 v48, 16, v58
    v_and_b32 v49, 0xffff0000, v58
    v_add_f32 v48, v48, v55
    v_add_f32 v49, v49, v56
    v_cvt_pk_bf16_f32 v39, v48, v49
    buffer_store_dwordx4 v[36:39], v5, s[28:31], s23 offen
    s_branch K4A_END
K4A_FFN:
    s_mov_b32 s12, s4
    s_mov_b32 s13, s5
    s_mov_b32 s14, 0x1c0000
    s_mov_b32 s15, 0x00020000
    s_mov_b32 s16, s6
    s_mov_b32 s17, s7
    s_mov_b32 s18, 0x1c0000
    s_mov_b32 s19, 0x00020000
    s_mov_b32 s28, s10
    s_mov_b32 s29, s11
    s_mov_b32 s30, 0x1c0000
    s_mov_b32 s31, 0x00020000
    s_mov_b32 s48, s44
    s_mov_b32 s49, s45
    s_mov_b32 s50, 0x400
    s_mov_b32 s51, 0x00020000
    s_mov_b32 s39, 0xffff0000
    s_cmp_ge_u32 s21, 4
    s_cbranch_scc1 K4A_NOPS
    v_lshlrev_b32 v20, 4, v0
    s_mov_b32 s38, 0xc80000
    buffer_load_dwordx4 v[32:35], v20, s[24:27], s38 offen
    s_add_u32 s38, s38, 4096
    buffer_load_dwordx4 v[36:39], v20, s[24:27], s38 offen
    s_add_u32 s38, s38, 4096
    buffer_load_dwordx4 v[40:43], v20, s[24:27], s38 offen
    s_add_u32 s38, s38, 4096
    buffer_load_dwordx4 v[44:47], v20, s[24:27], s38 offen
    s_add_u32 s38, s38, 4096
    buffer_load_dwordx4 v[48:51], v20, s[24:27], s38 offen
    s_add_u32 s38, s38, 4096
    buffer_load_dwordx4 v[52:55], v20, s[24:27], s38 offen
    s_add_u32 s38, s38, 4096
    buffer_load_dwordx4 v[56:59], v20, s[24:27], s38 offen
    s_add_u32 s38, s38, 4096
    buffer_load_dwordx4 v[60:63], v20, s[24:27], s38 offen
    s_add_u32 s38, s38, 4096
    buffer_load_dwordx4 v[64:67], v20, s[24:27], s38 offen
    s_add_u32 s38, s38, 4096
    buffer_load_dwordx4 v[68:71], v20, s[24:27], s38 offen
    s_add_u32 s38, s38, 4096
    buffer_load_dwordx4 v[72:75], v20, s[24:27], s38 offen
    s_add_u32 s38, s38, 4096
    buffer_load_dwordx4 v[76:79], v20, s[24:27], s38 offen
    s_add_u32 s38, s38, 4096
    buffer_load_dwordx4 v[80:83], v20, s[24:27], s38 offen
    s_add_u32 s38, s38, 4096
    buffer_load_dwordx4 v[84:87], v20, s[24:27], s38 offen
    s_add_u32 s38, s38, 4096
    buffer_load_dwordx4 v[88:91], v20, s[24:27], s38 offen
    s_add_u32 s38, s38, 4096
    buffer_load_dwordx4 v[92:95], v20, s[24:27], s38 offen
    s_add_u32 s38, s38, 4096
    buffer_load_dwordx4 v[96:99], v20, s[24:27], s38 offen
    s_add_u32 s38, s38, 4096
    buffer_load_dwordx4 v[100:103], v20, s[24:27], s38 offen
    s_add_u32 s38, s38, 4096
    buffer_load_dwordx4 v[104:107], v20, s[24:27], s38 offen
    s_add_u32 s38, s38, 4096
    buffer_load_dwordx4 v[108:111], v20, s[24:27], s38 offen
    s_add_u32 s38, s38, 4096
    buffer_load_dwordx4 v[112:115], v20, s[24:27], s38 offen
    s_add_u32 s38, s38, 4096
    buffer_load_dwordx4 v[116:119], v20, s[24:27], s38 offen
    s_add_u32 s38, s38, 4096
    buffer_load_dwordx4 v[120:123], v20, s[24:27], s38 offen
    s_add_u32 s38, s38, 4096
    buffer_load_dwordx4 v[124:127], v20, s[24:27], s38 offen
    s_add_u32 s38, s38, 4096
K4A_NOPS:
    s_add_u32 s32, s8, 0xc98000
    s_addc_u32 s33, s9, 0
    s_load_dwordx4 s[56:59], s[32:33], 0
    v_lshrrev_b32 v7, 2, v2
    v_mul_u32_u24 v7, 0xe00, v7
    v_and_b32 v3, 3, v2
    v_lshl_add_u32 v7, v3, 4, v7
    s_lshl_b32 s22, s2, 6
    s_mul_i32 s23, s21, 114688
    s_add_u32 s22, s22, s23
    s_lshl_b32 s23, s21, 11
    s_add_u32 s36, s23, 0
    s_mov_b32 m0, s36
    s_add_u32 s37, s22, 0
    buffer_load_dwordx4 v7, s[12:15], s37 offen lds
    s_add_u32 s36, s23, 32768
    s_mov_b32 m0, s36
    s_add_u32 s37, s22, 0
    buffer_load_dwordx4 v7, s[16:19], s37 offen lds
    s_add_u32 s36, s23, 1024
    s_mov_b32 m0, s36
    s_add_u32 s37, s22, 57344
    buffer_load_dwordx4 v7, s[12:15], s37 offen lds
    s_add_u32 s36, s23, 33792
    s_mov_b32 m0, s36
    s_add_u32 s37, s22, 57344
    buffer_load_dwordx4 v7, s[16:19], s37 offen lds
    s_lshl_b32 s22, s2, 15
    s_add_u32 s22, s22, s23
    s_add_u32 s36, s23, 65536
    s_mov_b32 m0, s36
    s_add_u32 s37, s22, 0
    buffer_load_dwordx4 v5, s[28:31], s37 offen lds
    s_add_u32 s36, s23, 66560
    s_mov_b32 m0, s36
    s_add_u32 s37, s22, 1024
    buffer_load_dwordx4 v5, s[28:31], s37 offen lds
    v_and_b32 v4, 255, v0
    v_lshlrev_b32 v6, 2, v4
    buffer_load_dword v19, v6, s[48:51], 0 offen
    v_mov_b32 v8, 0
    v_mov_b32 v9, 0
    v_mov_b32 v10, 100352
    ds_write_b64 v10, v[8:9]
    ds_write_b64 v10, v[8:9] offset:8
    s_cmp_ge_u32 s21, 4
    s_cbranch_scc1 K4A_RDONE
    s_waitcnt vmcnt(7) lgkmcnt(0)
    v_mov_b32 v8, s56
    v_add_f32 v8, s57, v8
    v_add_f32 v8, s58, v8
    v_add_f32 v8, s59, v8
    v_lshlrev_b32 v21, 3, v0
    v_sub_u32 v21, 0x7ff, v21
    v_mov_b32 v10, 0
    v_mov_b32 v11, 0
    v_add_f32 v32, v32, v33
    v_add_f32 v34, v34, v35
    v_add_f32 v32, v32, v34
    v_add_f32 v36, v36, v37
    v_add_f32 v38, v38, v39
    v_add_f32 v36, v36, v38
    v_add_f32 v40, v40, v41
    v_add_f32 v42, v42, v43
    v_add_f32 v40, v40, v42
    v_mul_f32 v32, 0x3b000000, v32
    v_mul_f32 v36, 0x3b000000, v36
    v_fma_f32 v36, -v32, v32, v36
    v_add_f32 v36, 0x3727c5ac, v36
    v_rsq_f32 v36, v36
    v_fma_f32 v40, -v32, v8, v40
    v_subrev_u32 v32, 0, v21
    v_mul_f32 v40, v40, v36
    v_cvt_pk_bf16_f32 v40, v40, v40
    v_lshlrev_b32 v40, 16, v40
    v_ashrrev_i32 v36, 31, v40
    v_or_b32 v36, 0x80000000, v36
    v_xor_b32 v40, v40, v36
    v_and_or_b32 v40, v40, s39, v32
    v_min_u32 v22, v10, v40
    v_max_u32 v10, v10, v40
    v_max_u32 v11, v11, v22
    v_add_f32 v44, v44, v45
    v_add_f32 v46, v46, v47
    v_add_f32 v44, v44, v46
    v_add_f32 v48, v48, v49
    v_add_f32 v50, v50, v51
    v_add_f32 v48, v48, v50
    v_add_f32 v52, v52, v53
    v_add_f32 v54, v54, v55
    v_add_f32 v52, v52, v54
    v_mul_f32 v44, 0x3b000000, v44
    v_mul_f32 v48, 0x3b000000, v48
    v_fma_f32 v48, -v44, v44, v48
    v_add_f32 v48, 0x3727c5ac, v48
    v_rsq_f32 v48, v48
    v_fma_f32 v52, -v44, v8, v52
    v_subrev_u32 v44, 1, v21
    v_mul_f32 v52, v52, v48
    v_cvt_pk_bf16_f32 v52, v52, v52
    v_lshlrev_b32 v52, 16, v52
    v_ashrrev_i32 v48, 31, v52
    v_or_b32 v48, 0x80000000, v48
    v_xor_b32 v52, v52, v48
    v_and_or_b32 v52, v52, s39, v44
    v_min_u32 v22, v10, v52
    v_max_u32 v10, v10, v52
    v_max_u32 v11, v11, v22
    v_add_f32 v56, v56, v57
    v_add_f32 v58, v58, v59
    v_add_f32 v56, v56, v58
    v_add_f32 v60, v60, v61
    v_add_f32 v62, v62, v63
    v_add_f32 v60, v60, v62
    v_add_f32 v64, v64, v65
    v_add_f32 v66, v66, v67
    v_add_f32 v64, v64, v66
    v_mul_f32 v56, 0x3b000000, v56
    v_mul_f32 v60, 0x3b000000, v60
    v_fma_f32 v60, -v56, v56, v60
    v_add_f32 v60, 0x3727c5ac, v60
    v_rsq_f32 v60, v60
    v_fma_f32 v64, -v56, v8, v64
    v_subrev_u32 v56, 2, v21
    v_mul_f32 v64, v64, v60
    v_cvt_pk_bf16_f32 v64, v64, v64
    v_lshlrev_b32 v64, 16, v64
    v_ashrrev_i32 v60, 31, v64
    v_or_b32 v60, 0x80000000, v60
    v_xor_b32 v64, v64, v60
    v_and_or_b32 v64, v64, s39, v56
    v_min_u32 v22, v10, v64
    v_max_u32 v10, v10, v64
    v_max_u32 v11, v11, v22
    v_add_f32 v68, v68, v69
    v_add_f32 v70, v70, v71
    v_add_f32 v68, v68, v70
    v_add_f32 v72, v72, v73
    v_add_f32 v74, v74, v75
    v_add_f32 v72, v72, v74
    v_add_f32 v76, v76, v77
    v_add_f32 v78, v78, v79
    v_add_f32 v76, v76, v78
    v_mul_f32 v68, 0x3b000000, v68
    v_mul_f32 v72, 0x3b000000, v72
    v_fma_f32 v72, -v68, v68, v72
    v_add_f32 v72, 0x3727c5ac, v72
    v_rsq_f32 v72, v72
    v_fma_f32 v76, -v68, v8, v76
    v_subrev_u32 v68, 3, v21
    v_mul_f32 v76, v76, v72
    v_cvt_pk_bf16_f32 v76, v76, v76
    v_lshlrev_b32 v76, 16, v76
    v_ashrrev_i32 v72, 31, v76
    v_or_b32 v72, 0x80000000, v72
    v_xor_b32 v76, v76, v72
    v_and_or_b32 v76, v76, s39, v68
    v_min_u32 v22, v10, v76
    v_max_u32 v10, v10, v76
    v_max_u32 v11, v11, v22
    v_add_f32 v80, v80, v81
    v_add_f32 v82, v82, v83
    v_add_f32 v80, v80, v82
    v_add_f32 v84, v84, v85
    v_add_f32 v86, v86, v87
    v_add_f32 v84, v84, v86
    v_add_f32 v88, v88, v89
    v_add_f32 v90, v90, v91
    v_add_f32 v88, v88, v90
    v_mul_f32 v80, 0x3b000000, v80
    v_mul_f32 v84, 0x3b000000, v84
    v_fma_f32 v84, -v80, v80, v84
    v_add_f32 v84, 0x3727c5ac, v84
    v_rsq_f32 v84, v84
    v_fma_f32 v88, -v80, v8, v88
    v_subrev_u32 v80, 4, v21
    v_mul_f32 v88, v88, v84
    v_cvt_pk_bf16_f32 v88, v88, v88
    v_lshlrev_b32 v88, 16, v88
    v_ashrrev_i32 v84, 31, v88
    v_or_b32 v84, 0x80000000, v84
    v_xor_b32 v88, v88, v84
    v_and_or_b32 v88, v88, s39, v80
    v_min_u32 v22, v10, v88
    v_max_u32 v10, v10, v88
    v_max_u32 v11, v11, v22
    v_add_f32 v92, v92, v93
    v_add_f32 v94, v94, v95
    v_add_f32 v92, v92, v94
    v_add_f32 v96, v96, v97
    v_add_f32 v98, v98, v99
    v_add_f32 v96, v96, v98
    v_add_f32 v100, v100, v101
    v_add_f32 v102, v102, v103
    v_add_f32 v100, v100, v102
    v_mul_f32 v92, 0x3b000000, v92
    v_mul_f32 v96, 0x3b000000, v96
    v_fma_f32 v96, -v92, v92, v96
    v_add_f32 v96, 0x3727c5ac, v96
    v_rsq_f32 v96, v96
    v_fma_f32 v100, -v92, v8, v100
    v_subrev_u32 v92, 5, v21
    v_mul_f32 v100, v100, v96
    v_cvt_pk_bf16_f32 v100, v100, v100
    v_lshlrev_b32 v100, 16, v100
    v_ashrrev_i32 v96, 31, v100
    v_or_b32 v96, 0x80000000, v96
    v_xor_b32 v100, v100, v96
    v_and_or_b32 v100, v100, s39, v92
    v_min_u32 v22, v10, v100
    v_max_u32 v10, v10, v100
    v_max_u32 v11, v11, v22
    v_add_f32 v104, v104, v105
    v_add_f32 v106, v106, v107
    v_add_f32 v104, v104, v106
    v_add_f32 v108, v108, v109
    v_add_f32 v110, v110, v111
    v_add_f32 v108, v108, v110
    v_add_f32 v112, v112, v113
    v_add_f32 v114, v114, v115
    v_add_f32 v112, v112, v114
    v_mul_f32 v104, 0x3b000000, v104
    v_mul_f32 v108, 0x3b000000, v108
    v_fma_f32 v108, -v104, v104, v108
    v_add_f32 v108, 0x3727c5ac, v108
    v_rsq_f32 v108, v108
    v_fma_f32 v112, -v104, v8, v112
    v_subrev_u32 v104, 6, v21
    v_mul_f32 v112, v112, v108
    v_cvt_pk_bf16_f32 v112, v112, v112
    v_lshlrev_b32 v112, 16, v112
    v_ashrrev_i32 v108, 31, v112
    v_or_b32 v108, 0x80000000, v108
    v_xor_b32 v112, v112, v108
    v_and_or_b32 v112, v112, s39, v104
    v_min_u32 v22, v10, v112
    v_max_u32 v10, v10, v112
    v_max_u32 v11, v11, v22
    v_add_f32 v116, v116, v117
    v_add_f32 v118, v118, v119
    v_add_f32 v116, v116, v118
    v_add_f32 v120, v120, v121
    v_add_f32 v122, v122, v123
    v_add_f32 v120, v120, v122
    v_add_f32 v124, v124, v125
    v_add_f32 v126, v126, v127
    v_add_f32 v124, v124, v126
    v_mul_f32 v116, 0x3b000000, v116
    v_mul_f32 v120, 0x3b000000, v120
    v_fma_f32 v120, -v116, v116, v120
    v_add_f32 v120, 0x3727c5ac, v120
    v_rsq_f32 v120, v120
    v_fma_f32 v124, -v116, v8, v124
    v_subrev_u32 v116, 7, v21
    v_mul_f32 v124, v124, v120
    v_cvt_pk_bf16_f32 v124, v124, v124
    v_lshlrev_b32 v124, 16, v124
    v_ashrrev_i32 v120, 31, v124
    v_or_b32 v120, 0x80000000, v120
    v_xor_b32 v124, v124, v120
    v_and_or_b32 v124, v124, s39, v116
    v_min_u32 v22, v10, v124
    v_max_u32 v10, v10, v124
    v_max_u32 v11, v11, v22
    s_nop 1
    v_mov_b32_dpp v12, v10 row_ror:8 row_mask:0xf bank_mask:0xf
    v_mov_b32_dpp v13, v11 row_ror:8 row_mask:0xf bank_mask:0xf
    v_min_u32 v22, v10, v12
    v_max_u32 v10, v10, v12
    v_max_u32 v11, v11, v13
    v_max_u32 v11, v11, v22
    s_nop 1
    v_mov_b32_dpp v12, v10 row_ror:4 row_mask:0xf bank_mask:0xf
    v_mov_b32_dpp v13, v11 row_ror:4 row_mask:0xf bank_mask:0xf
    v_min_u32 v22, v10, v12
    v_max_u32 v10, v10, v12
    v_max_u32 v11, v11, v13
    v_max_u32 v11, v11, v22
    s_nop 1
    v_mov_b32_dpp v12, v10 row_ror:2 row_mask:0xf bank_mask:0xf
    v_mov_b32_dpp v13, v11 row_ror:2 row_mask:0xf bank_mask:0xf
    v_min_u32 v22, v10, v12
    v_max_u32 v10, v10, v12
    v_max_u32 v11, v11, v13
    v_max_u32 v11, v11, v22
    s_nop 1
    v_mov_b32_dpp v12, v10 row_ror:1 row_mask:0xf bank_mask:0xf
    v_mov_b32_dpp v13, v11 row_ror:1 row_mask:0xf bank_mask:0xf
    v_min_u32 v22, v10, v12
    v_max_u32 v10, v10, v12
    v_max_u32 v11, v11, v13
    v_max_u32 v11, v11, v22
    v_lshrrev_b32 v22, 4, v0
    v_lshlrev_b32 v22, 3, v22
    v_add_u32 v22, 100416, v22
    ds_write_b64 v22, v[10:11]
K4A_RDONE:
    s_waitcnt lgkmcnt(0)
    s_barrier
    s_cmp_ge_u32 s21, 8
    s_cbranch_scc1 K4A_XDONE
    v_and_b32 v22, 15, v2
    v_lshlrev_b32 v22, 3, v22
    v_add_u32 v22, 100416, v22
    ds_read_b64 v[10:11], v22
    s_waitcnt lgkmcnt(0)
    s_nop 1
    v_mov_b32_dpp v12, v10 row_ror:8 row_mask:0xf bank_mask:0xf
    v_mov_b32_dpp v13, v11 row_ror:8 row_mask:0xf bank_mask:0xf
    v_min_u32 v22, v10, v12
    v_max_u32 v10, v10, v12
    v_max_u32 v11, v11, v13
    v_max_u32 v11, v11, v22
    s_nop 1
    v_mov_b32_dpp v12, v10 row_ror:4 row_mask:0xf bank_mask:0xf
    v_mov_b32_dpp v13, v11 row_ror:4 row_mask:0xf bank_mask:0xf
    v_min_u32 v22, v10, v12
    v_max_u32 v10, v10, v12
    v_max_u32 v11, v11, v13
    v_max_u32 v11, v11, v22
    s_nop 1
    v_mov_b32_dpp v12, v10 row_ror:2 row_mask:0xf bank_mask:0xf
    v_mov_b32_dpp v13, v11 row_ror:2 row_mask:0xf bank_mask:0xf
    v_min_u32 v22, v10, v12
    v_max_u32 v10, v10, v12
    v_max_u32 v11, v11, v13
    v_max_u32 v11, v11, v22
    s_nop 1
    v_mov_b32_dpp v12, v10 row_ror:1 row_mask:0xf bank_mask:0xf
    v_mov_b32_dpp v13, v11 row_ror:1 row_mask:0xf bank_mask:0xf
    v_min_u32 v22, v10, v12
    v_max_u32 v10, v10, v12
    v_max_u32 v11, v11, v13
    v_max_u32 v11, v11, v22
    s_nop 0
    v_readfirstlane_b32 s56, v10
    v_readfirstlane_b32 s57, v11
    s_nop 2
    s_and_b32 s60, s56, 0x7ff
    s_sub_u32 s60, 0x7ff, s60
    s_and_b32 s61, s57, 0x7ff
    s_sub_u32 s61, 0x7ff, s61
    s_cmp_lt_u32 s21, 4
    s_cselect_b32 s63, s60, s61
    s_lshl_b32 s62, s63, 10
    s_add_u32 s62, s62, 0x800000
    buffer_load_dword v40, v6, s[24:27], s62 offen
    s_and_b32 s62, s63, 7
    s_mul_i32 s62, s62, 0x3000
    s_lshr_b32 s34, s63, 3
    s_lshl_b32 s34, s34, 4
    s_add_u32 s62, s62, s34
    s_add_u32 s62, s62, 0xc80000
    s_add_u32 s32, s8, s62
    s_addc_u32 s33, s9, 0
    s_load_dwordx4 s[64:67], s[32:33], 0
    s_load_dwordx4 s[68:71], s[32:33], 4096
    v_lshlrev_b32 v17, 16, v19
    v_and_b32 v18, 0xffff0000, v19
    v_lshlrev_b32 v23, 2, v0
    v_add_u32 v23, 98304, v23
    s_waitcnt lgkmcnt(0)
    v_mov_b32 v8, s64
    v_add_f32 v8, s65, v8
    v_add_f32 v8, s66, v8
    v_add_f32 v8, s67, v8
    v_mov_b32 v9, s68
    v_add_f32 v9, s69, v9
    v_add_f32 v9, s70, v9
    v_add_f32 v9, s71, v9
    v_mul_f32 v8, 0x3b000000, v8
    v_mul_f32 v9, 0x3b000000, v9
    v_fma_f32 v9, -v8, v8, v9
    v_max_f32 v9, 0, v9
    v_cvt_pk_bf16_f32 v8, v8, v8
    v_lshlrev_b32 v8, 16, v8
    v_cvt_pk_bf16_f32 v9, v9, v9
    v_lshlrev_b32 v9, 16, v9
    v_add_f32 v9, 0x3727c5ac, v9
    v_cvt_pk_bf16_f32 v9, v9, v9
    v_lshlrev_b32 v9, 16, v9
    v_sqrt_f32 v9, v9
    s_nop 0
    v_cvt_pk_bf16_f32 v9, v9, v9
    v_lshlrev_b32 v9, 16, v9
    v_rcp_f32 v10, v9
    s_nop 0
    s_waitcnt vmcnt(0)
    v_lshlrev_b32 v31, 16, v40
    v_and_b32 v32, 0xffff0000, v40
    v_sub_f32 v24, v31, v8
    v_sub_f32 v25, v32, v8
    v_cvt_pk_bf16_f32 v26, v24, v25
    v_lshlrev_b32 v24, 16, v26
    v_and_b32 v25, 0xffff0000, v26
    v_mul_f32 v27, v24, v10
    v_mul_f32 v28, v25, v10
    v_fma_f32 v29, -v27, v9, v24
    v_fma_f32 v30, -v28, v9, v25
    v_fmac_f32 v27, v29, v10
    v_fmac_f32 v28, v30, v10
    v_cvt_pk_bf16_f32 v41, v27, v28
    v_lshlrev_b32 v24, 16, v41
    v_and_b32 v25, 0xffff0000, v41
    ds_write_b32 v23, v41
    v_mul_f32 v16, v24, v17
    v_fmac_f32 v16, v25, v18
    s_nop 1
    v_add_f32_dpp v16, v16, v16 row_ror:8 row_mask:0xf bank_mask:0xf
    s_nop 1
    v_add_f32_dpp v16, v16, v16 row_ror:4 row_mask:0xf bank_mask:0xf
    s_nop 1
    v_add_f32_dpp v16, v16, v16 row_ror:2 row_mask:0xf bank_mask:0xf
    s_nop 1
    v_add_f32_dpp v16, v16, v16 row_ror:1 row_mask:0xf bank_mask:0xf
    v_lshrrev_b32 v22, 4, v0
    v_lshlrev_b32 v22, 2, v22
    v_add_u32 v22, 103104, v22
    ds_write_b32 v22, v16
K4A_XDONE:
    s_waitcnt vmcnt(0) lgkmcnt(0)
    s_barrier
    v_and_b32 v3, 31, v2
    v_lshrrev_b32 v4, 5, v2
    v_cmp_gt_u32 vcc, 2, v3
    v_and_b32 v7, 15, v2
    v_lshrrev_b32 v8, 2, v7
    v_and_b32 v9, 3, v7
    v_lshl_add_u32 v8, v4, 3, v8
    v_bfe_u32 v7, v2, 4, 1
    v_lshlrev_b32 v7, 5, v7
    v_lshl_add_u32 v7, v9, 3, v7
    v_mov_b32 v11, 100352
    s_cmp_ge_u32 s21, 8
    s_cbranch_scc1 K4A_GDONE
    s_and_b32 s36, s21, 1
    s_lshr_b32 s37, s21, 1
    s_lshl_b32 s38, s36, 15
    s_lshl_b32 s39, s37, 13
    s_add_u32 s38, s38, s39
    v_lshl_add_u32 v12, v8, 6, v7
    v_add_u32 v12, s38, v12
    s_lshl_b32 s39, s37, 8
    s_add_u32 s39, s39, 98304
    v_lshlrev_b32 v13, 10, v3
    v_lshl_add_u32 v13, v4, 4, v13
    v_add_u32 v13, s39, v13
    v_mov_b32 v14, 32
    v_cndmask_b32 v13, v11, v13, vcc
    v_cndmask_b32 v14, 0, v14, vcc
    v_mov_b32 v64, 0
    v_mov_b32 v65, 0
    v_mov_b32 v66, 0
    v_mov_b32 v67, 0
    v_mov_b32 v68, 0
    v_mov_b32 v69, 0
    v_mov_b32 v70, 0
    v_mov_b32 v71, 0
    v_mov_b32 v72, 0
    v_mov_b32 v73, 0
    v_mov_b32 v74, 0
    v_mov_b32 v75, 0
    v_mov_b32 v76, 0
    v_mov_b32 v77, 0
    v_mov_b32 v78, 0
    v_mov_b32 v79, 0
    ds_read_b128 v[32:35], v13
    ds_read_b64_tr_b16 v[40:41], v12 offset:0
    ds_read_b64_tr_b16 v[42:43], v12 offset:256
    v_add_u32 v13, v14, v13
    s_waitcnt lgkmcnt(0)
    v_mfma_f32_32x32x16_bf16 v[64:79], v[32:35], v[40:43], v[64:79]
    ds_read_b128 v[36:39], v13
    ds_read_b64_tr_b16 v[44:45], v12 offset:1024
    ds_read_b64_tr_b16 v[46:47], v12 offset:1280
    v_add_u32 v13, v14, v13
    s_waitcnt lgkmcnt(0)
    v_mfma_f32_32x32x16_bf16 v[64:79], v[36:39], v[44:47], v[64:79]
    ds_read_b128 v[32:35], v13
    ds_read_b64_tr_b16 v[40:41], v12 offset:2048
    ds_read_b64_tr_b16 v[42:43], v12 offset:2304
    v_add_u32 v13, v14, v13
    s_waitcnt lgkmcnt(0)
    v_mfma_f32_32x32x16_bf16 v[64:79], v[32:35], v[40:43], v[64:79]
    ds_read_b128 v[36:39], v13
    ds_read_b64_tr_b16 v[44:45], v12 offset:3072
    ds_read_b64_tr_b16 v[46:47], v12 offset:3328
    v_add_u32 v13, v14, v13
    s_waitcnt lgkmcnt(0)
    v_mfma_f32_32x32x16_bf16 v[64:79], v[36:39], v[44:47], v[64:79]
    ds_read_b128 v[32:35], v13
    ds_read_b64_tr_b16 v[40:41], v12 offset:4096
    ds_read_b64_tr_b16 v[42:43], v12 offset:4352
    v_add_u32 v13, v14, v13
    s_waitcnt lgkmcnt(0)
    v_mfma_f32_32x32x16_bf16 v[64:79], v[32:35], v[40:43], v[64:79]
    ds_read_b128 v[36:39], v13
    ds_read_b64_tr_b16 v[44:45], v12 offset:5120
    ds_read_b64_tr_b16 v[46:47], v12 offset:5376
    v_add_u32 v13, v14, v13
    s_waitcnt lgkmcnt(0)
    v_mfma_f32_32x32x16_bf16 v[64:79], v[36:39], v[44:47], v[64:79]
    ds_read_b128 v[32:35], v13
    ds_read_b64_tr_b16 v[40:41], v12 offset:6144
    ds_read_b64_tr_b16 v[42:43], v12 offset:6400
    v_add_u32 v13, v14, v13
    s_waitcnt lgkmcnt(0)
    v_mfma_f32_32x32x16_bf16 v[64:79], v[32:35], v[40:43], v[64:79]
    ds_read_b128 v[36:39], v13
    ds_read_b64_tr_b16 v[44:45], v12 offset:7168
    ds_read_b64_tr_b16 v[46:47], v12 offset:7424
    v_add_u32 v13, v14, v13
    s_waitcnt lgkmcnt(0)
    v_mfma_f32_32x32x16_bf16 v[64:79], v[36:39], v[44:47], v[64:79]
    s_nop 15
    s_lshl_b32 s38, s37, 9
    s_lshl_b32 s39, s36, 8
    s_add_u32 s38, s38, s39
    s_add_u32 s38, s38, 100928
    v_lshlrev_b32 v15, 2, v3
    v_add_u32 v15, s38, v15
    v_cmp_eq_u32 s[66:67], 0, v4
    s_and_saveexec_b64 s[68:69], s[66:67]
    ds_write_b32 v15, v64
    ds_write_b32 v15, v65 offset:128
    s_mov_b64 exec, s[68:69]
K4A_GDONE:
    s_waitcnt lgkmcnt(0)
    s_barrier
    s_cmp_lg_u32 s21, 0
    s_cbranch_scc1 K4A_ADONE
    v_lshlrev_b32 v12, 2, v2
    v_add_u32 v12, 100928, v12
    ds_read_b32 v32, v12 offset:0
    ds_read_b32 v36, v12 offset:256
    ds_read_b32 v33, v12 offset:512
    ds_read_b32 v37, v12 offset:768
    ds_read_b32 v34, v12 offset:1024
    ds_read_b32 v38, v12 offset:1280
    ds_read_b32 v35, v12 offset:1536
    ds_read_b32 v39, v12 offset:1792
    s_waitcnt lgkmcnt(0)
    v_add_f32 v32, v32, v33
    v_add_f32 v34, v34, v35
    v_add_f32 v32, v32, v34
    v_add_f32 v36, v36, v37
    v_add_f32 v38, v38, v39
    v_add_f32 v36, v36, v38
    v_cvt_pk_bf16_f32 v13, v32, v32
    v_lshlrev_b32 v13, 16, v13
    v_cvt_pk_bf16_f32 v15, v36, v36
    v_lshlrev_b32 v15, 16, v15
    v_mul_f32 v14, 0xbfb8aa3b, v13
    v_exp_f32 v14, v14
    s_nop 0
    v_add_f32 v14, 1.0, v14
    v_rcp_f32 v16, v14
    s_nop 0
    v_mul_f32 v17, v13, v16
    v_fma_f32 v18, -v17, v14, v13
    v_fmac_f32 v17, v18, v16
    v_cvt_pk_bf16_f32 v17, v17, v17
    v_lshlrev_b32 v17, 16, v17
    v_mul_f32 v17, v17, v15
    v_cvt_pk_bf16_f32 v17, v17, v17
    v_lshlrev_b32 v12, 1, v2
    v_add_u32 v12, 102976, v12
    ds_write_b16 v12, v17
K4A_ADONE:
    s_waitcnt lgkmcnt(0)
    s_barrier
    s_lshl_b32 s38, s21, 6
    s_add_u32 s38, s38, 65536
    v_lshl_add_u32 v12, v8, 10, v7
    v_add_u32 v12, s38, v12
    v_lshlrev_b32 v13, 6, v3
    v_lshl_add_u32 v13, v4, 4, v13
    v_add_u32 v13, 102976, v13
    v_add_u32 v14, 32, v13
    v_cndmask_b32 v13, v11, v13, vcc
    v_cndmask_b32 v14, v11, v14, vcc
    ds_read_b128 v[32:35], v13
    ds_read_b64_tr_b16 v[40:41], v12 offset:0
    ds_read_b64_tr_b16 v[42:43], v12 offset:4096
    ds_read_b128 v[36:39], v14
    ds_read_b64_tr_b16 v[44:45], v12 offset:16384
    ds_read_b64_tr_b16 v[46:47], v12 offset:20480
    s_waitcnt lgkmcnt(0)
    v_mfma_f32_32x32x16_bf16 v[64:79], v[32:35], v[40:43], 0
    v_mfma_f32_32x32x16_bf16 v[64:79], v[36:39], v[44:47], v[64:79]
    v_lshlrev_b32 v15, 2, v3
    s_lshl_b32 s36, s2, 12
    s_lshl_b32 s37, s21, 7
    s_add_u32 s36, s36, s37
    s_add_u32 s36, s36, 0xca0000
    v_cmp_eq_u32 s[66:67], 0, v4
    s_nop 15
    s_and_saveexec_b64 s[68:69], s[66:67]
    buffer_store_dword v64, v15, s[24:27], s36 offen
    buffer_store_dword v65, v15, s[24:27], s36 offen offset:2048
    s_mov_b64 exec, s[68:69]
    s_cmp_lg_u32 s2, 0
    s_cbranch_scc1 K4A_END
    s_cmp_lg_u32 s21, 0
    s_cbranch_scc1 K4A_END
    v_lshlrev_b32 v9, 2, v2
    v_add_u32 v9, 103104, v9
    ds_read_b32 v16, v9
    s_waitcnt lgkmcnt(0)
    s_nop 1
    v_add_f32_dpp v16, v16, v16 row_ror:8 row_mask:0xf bank_mask:0xf
    s_nop 1
    v_add_f32_dpp v16, v16, v16 row_ror:4 row_mask:0xf bank_mask:0xf
    s_nop 1
    v_add_f32_dpp v16, v16, v16 row_ror:2 row_mask:0xf bank_mask:0xf
    s_nop 1
    v_add_f32_dpp v16, v16, v16 row_ror:1 row_mask:0xf bank_mask:0xf
    v_cvt_pk_bf16_f32 v16, v16, v16
    v_lshlrev_b32 v16, 16, v16
    s_nop 0
    v_readlane_b32 s56, v16, 0
    v_readlane_b32 s57, v16, 16
    s_nop 1
    v_mov_b32 v18, s56
    v_mov_b32 v19, s57
    v_mov_b32 v16, s60
    v_mov_b32 v17, s61
    v_mov_b32 v20, 0
    s_mov_b32 s38, 0xc60000
    buffer_store_dwordx4 v[16:19], v20, s[24:27], s38 offen
K4A_END:
    s_endpgm
.globl k4b_ffn2_kernel
.p2align 8
.type k4b_ffn2_kernel,@function
k4b_ffn2_kernel:
    s_cmp_ge_u32 s2, 16
    s_cbranch_scc1 K4B_END
    s_load_dwordx2 s[8:9], s[0:1], 80
    s_load_dwordx2 s[10:11], s[0:1], 64
    v_lshrrev_b32 v1, 6, v0
    v_and_b32 v2, 63, v0
    s_nop 0
    v_readfirstlane_b32 s21, v1
    s_waitcnt lgkmcnt(0)
    s_mov_b32 s24, s8
    s_mov_b32 s25, s9
    s_mov_b32 s26, 0xe00000
    s_mov_b32 s27, 0x00020000
    s_mov_b32 s28, s10
    s_mov_b32 s29, s11
    s_mov_b32 s30, 0x200000
    s_mov_b32 s31, 0x00020000
    s_add_u32 s32, s8, 0xc60000
    s_addc_u32 s33, s9, 0
    s_load_dwordx4 s[60:63], s[32:33], 0
    v_lshlrev_b32 v5, 2, v2
    s_lshl_b32 s22, s2, 8
    s_mul_i32 s23, s21, 57344
    s_add_u32 s22, s22, s23
    s_add_u32 s22, s22, 0xca0000
    buffer_load_dword v32, v5, s[24:27], s22 offen
    s_add_u32 s22, s22, 4096
    buffer_load_dword v33, v5, s[24:27], s22 offen
    s_add_u32 s22, s22, 4096
    buffer_load_dword v34, v5, s[24:27], s22 offen
    s_add_u32 s22, s22, 4096
    buffer_load_dword v35, v5, s[24:27], s22 offen
    s_add_u32 s22, s22, 4096
    buffer_load_dword v36, v5, s[24:27], s22 offen
    s_add_u32 s22, s22, 4096
    buffer_load_dword v37, v5, s[24:27], s22 offen
    s_add_u32 s22, s22, 4096
    buffer_load_dword v38, v5, s[24:27], s22 offen
    s_add_u32 s22, s22, 4096
    buffer_load_dword v39, v5, s[24:27], s22 offen
    s_add_u32 s22, s22, 4096
    buffer_load_dword v40, v5, s[24:27], s22 offen
    s_add_u32 s22, s22, 4096
    buffer_load_dword v41, v5, s[24:27], s22 offen
    s_add_u32 s22, s22, 4096
    buffer_load_dword v42, v5, s[24:27], s22 offen
    s_add_u32 s22, s22, 4096
    buffer_load_dword v43, v5, s[24:27], s22 offen
    s_add_u32 s22, s22, 4096
    buffer_load_dword v44, v5, s[24:27], s22 offen
    s_add_u32 s22, s22, 4096
    buffer_load_dword v45, v5, s[24:27], s22 offen
    s_add_u32 s22, s22, 4096
    s_waitcnt lgkmcnt(0)
    s_lshr_b32 s34, s2, 3
    s_cmp_eq_u32 s34, 0
    s_cselect_b32 s35, s60, s61
    s_cselect_b32 s36, s62, s63
    s_and_b32 s37, s2, 7
    s_lshl_b32 s37, s37, 7
    s_lshl_b32 s38, s35, 10
    s_add_u32 s37, s37, s38
    v_lshlrev_b32 v6, 1, v2
    s_add_u32 s38, s37, 0x800000
    buffer_load_ushort v20, v6, s[24:27], s38 offen
    s_and_b32 s39, s35, 7
    s_mul_i32 s39, s39, 0x3000
    s_lshr_b32 s40, s35, 3
    s_lshl_b32 s40, s40, 4
    s_add_u32 s39, s39, s40
    s_add_u32 s39, s39, 0xc80000
    s_add_u32 s32, s8, s39
    s_addc_u32 s33, s9, 0
    s_load_dwordx4 s[64:67], s[32:33], 0
    s_load_dwordx4 s[68:71], s[32:33], 4096
    s_waitcnt vmcnt(1)
    v_add_f32 v32, v32, v33
    v_add_f32 v32, v32, v34
    v_add_f32 v32, v32, v35
    v_add_f32 v32, v32, v36
    v_add_f32 v32, v32, v37
    v_add_f32 v32, v32, v38
    v_add_f32 v32, v32, v39
    v_add_f32 v32, v32, v40
    v_add_f32 v32, v32, v41
    v_add_f32 v32, v32, v42
    v_add_f32 v32, v32, v43
    v_add_f32 v32, v32, v44
    v_add_f32 v32, v32, v45
    v_lshlrev_b32 v7, 2, v0
    ds_write_b32 v7, v32
    s_waitcnt lgkmcnt(0)
    s_barrier
    s_cmp_lg_u32 s21, 0
    s_cbranch_scc1 K4B_END
    ds_read_b32 v32, v5 offset:0
    ds_read_b32 v33, v5 offset:256
    ds_read_b32 v34, v5 offset:512
    ds_read_b32 v35, v5 offset:768
    v_mov_b32 v8, s64
    v_add_f32 v8, s65, v8
    v_add_f32 v8, s66, v8
    v_add_f32 v8, s67, v8
    v_mov_b32 v9, s68
    v_add_f32 v9, s69, v9
    v_add_f32 v9, s70, v9
    v_add_f32 v9, s71, v9
    v_mul_f32 v8, 0x3b000000, v8
    v_mul_f32 v9, 0x3b000000, v9
    v_fma_f32 v9, -v8, v8, v9
    v_max_f32 v9, 0, v9
    v_cvt_pk_bf16_f32 v8, v8, v8
    v_lshlrev_b32 v8, 16, v8
    v_cvt_pk_bf16_f32 v9, v9, v9
    v_lshlrev_b32 v9, 16, v9
    v_add_f32 v9, 0x3727c5ac, v9
    v_cvt_pk_bf16_f32 v9, v9, v9
    v_lshlrev_b32 v9, 16, v9
    v_sqrt_f32 v9, v9
    s_nop 0
    v_cvt_pk_bf16_f32 v9, v9, v9
    v_lshlrev_b32 v9, 16, v9
    v_rcp_f32 v10, v9
    s_nop 0
    v_mov_b32 v23, s36
    v_mul_f32 v24, 0xbfb8aa3b, v23
    v_exp_f32 v24, v24
    s_nop 0
    v_add_f32 v24, 1.0, v24
    v_rcp_f32 v25, v24
    s_nop 0
    v_fma_f32 v26, -v25, v24, 1.0
    v_fmac_f32 v25, v26, v25
    v_cvt_pk_bf16_f32 v25, v25, v25
    v_lshlrev_b32 v25, 16, v25
    s_waitcnt vmcnt(0) lgkmcnt(0)
    v_add_f32 v32, v32, v34
    v_add_f32 v33, v33, v35
    v_add_f32 v32, v32, v33
    v_cvt_pk_bf16_f32 v32, v32, v32
    v_lshlrev_b32 v32, 16, v32
    v_mul_f32 v32, v32, v25
    v_cvt_pk_bf16_f32 v32, v32, v32
    v_lshlrev_b32 v32, 16, v32
    v_lshlrev_b32 v57, 16, v20
    v_and_b32 v58, 0xffff0000, v20
    v_sub_f32 v50, v57, v8
    v_sub_f32 v51, v58, v8
    v_cvt_pk_bf16_f32 v52, v50, v51
    v_lshlrev_b32 v50, 16, v52
    v_and_b32 v51, 0xffff0000, v52
    v_mul_f32 v53, v50, v10
    v_mul_f32 v54, v51, v10
    v_fma_f32 v55, -v53, v9, v50
    v_fma_f32 v56, -v54, v9, v51
    v_fmac_f32 v53, v55, v10
    v_fmac_f32 v54, v56, v10
    v_cvt_pk_bf16_f32 v60, v53, v54
    v_lshlrev_b32 v50, 16, v60
    v_and_b32 v51, 0xffff0000, v60
    v_add_f32 v50, v50, v32
    v_cvt_pk_bf16_f32 v50, v50, v50
    v_lshlrev_b32 v50, 16, v50
    v_add_f32 v50, v50, v57
    v_cvt_pk_bf16_f32 v50, v50, v50
    buffer_store_short v50, v6, s[28:31], s37 offen
K4B_END:
    s_endpgm
.section .rodata,"a"
.p2align 6
.amdhsa_kernel k1_qkv_kernel
  .amdhsa_next_free_vgpr 152
  .amdhsa_next_free_sgpr 102
  .amdhsa_accum_offset 152
  .amdhsa_group_segment_fixed_size 0
  .amdhsa_kernarg_size 88
  .amdhsa_user_sgpr_count 2
  .amdhsa_user_sgpr_kernarg_segment_ptr 1
  .amdhsa_system_sgpr_workgroup_id_x 1
.end_amdhsa_kernel
.p2align 6
.amdhsa_kernel k2_attn_kernel
  .amdhsa_next_free_vgpr 128
  .amdhsa_next_free_sgpr 102
  .amdhsa_accum_offset 128
  .amdhsa_group_segment_fixed_size 0
  .amdhsa_kernarg_size 88
  .amdhsa_user_sgpr_count 2
  .amdhsa_user_sgpr_kernarg_segment_ptr 1
  .amdhsa_system_sgpr_workgroup_id_x 1
.end_amdhsa_kernel
.p2align 6
.amdhsa_kernel k3_proj_kernel
  .amdhsa_next_free_vgpr 236
  .amdhsa_next_free_sgpr 102
  .amdhsa_accum_offset 236
  .amdhsa_group_segment_fixed_size 0
  .amdhsa_kernarg_size 88
  .amdhsa_user_sgpr_count 2
  .amdhsa_user_sgpr_kernarg_segment_ptr 1
  .amdhsa_system_sgpr_workgroup_id_x 1
.end_amdhsa_kernel
.p2align 6
.amdhsa_kernel k4a_ffn1_kernel
  .amdhsa_next_free_vgpr 128
  .amdhsa_next_free_sgpr 102
  .amdhsa_accum_offset 128
  .amdhsa_group_segment_fixed_size 0
  .amdhsa_kernarg_size 88
  .amdhsa_user_sgpr_count 2
  .amdhsa_user_sgpr_kernarg_segment_ptr 1
  .amdhsa_system_sgpr_workgroup_id_x 1
.end_amdhsa_kernel
.p2align 6
.amdhsa_kernel k4b_ffn2_kernel
  .amdhsa_next_free_vgpr 64
  .amdhsa_next_free_sgpr 102
  .amdhsa_accum_offset 64
  .amdhsa_group_segment_fixed_size 0
  .amdhsa_kernarg_size 88
  .amdhsa_user_sgpr_count 2
  .amdhsa_user_sgpr_kernarg_segment_ptr 1
  .amdhsa_system_sgpr_workgroup_id_x 1
.end_amdhsa_kernel
```
